```python
import torch

def _softmax(x, axis=-1):
    return torch.softmax(x, dim=axis)
def _gelu(x):
    return torch.nn.functional.gelu(x, approximate="tanh")
def _silu(x):
    return torch.nn.functional.silu(x)
def _sigmoid(x):
    return torch.sigmoid(x)
def _layernorm(x, axis=-1, eps=1e-5):
    m = x.mean(dim=axis, keepdim=True)
    v = x.var(dim=axis, keepdim=True, unbiased=False)
    return (x - m) / torch.sqrt(v + eps)
def _scatter_add(tgt, idx, src, axis=0):
    return tgt.clone().index_add_(axis, idx, src)
def _segment_sum(src, seg, n):
    out = torch.zeros((n,) + src.shape[1:], dtype=src.dtype)
    return out.index_add_(0, seg, src)
def _pad(x, pw):
    flat = tuple(v for pair in reversed(pw) for v in pair)
    return torch.nn.functional.pad(x, flat)

kernel_name = 'standalone__sliding_block_cached__sampling'

def setup_inputs():

    _w = (lambda a: (lambda t: t.to(torch.bfloat16) if t.is_floating_point() else t)(torch.as_tensor(a)))
    B, Sq, D = 8, 32, 576
    Hq, Hkv, Sk, Dh = 32, 16, 8192, 128
    assert Hq % Hkv == 0, (Hq, Hkv)
    return {
        "x": _w((lambda *s: torch.randn(*s, dtype=torch.bfloat16) * 0.8)(B, Sq, D)),
        "k_cache": _w((lambda *s: torch.randn(*s, dtype=torch.bfloat16) * 0.8)(B, Hkv, Sk, Dh)),
        "v_cache": _w((lambda *s: torch.randn(*s, dtype=torch.bfloat16) * 0.05)(B, Hkv, Sk, Dh)),
        "wq": _w((lambda *s: torch.randn(*s, dtype=torch.bfloat16) * 0.8)(D, Hq * Dh) * (D ** -0.5)),
        "wo": _w((lambda *s: torch.randn(*s, dtype=torch.bfloat16) * 0.05)(Hq * Dh, D) * ((Hq * Dh) ** -0.5)),
    }

def reference(x, k_cache, v_cache, wq, wo):
    B, Sq, D = x.shape
    Hq, Dh = 32, 128
    Hkv, Sk = k_cache.shape[1], k_cache.shape[2]
    W = min(4096, max(256, Sk // 4))
    rep = Hq // Hkv
    q = (lambda x, *d: x.permute(*d))((x @ wq).reshape(B, Sq, Hq, Dh), 0, 2, 1, 3)
    k = (lambda x, n, axis: torch.repeat_interleave(x, n, dim=axis))(k_cache[:, :, Sk - W:, :], rep, axis=1)
    v = (lambda x, n, axis: torch.repeat_interleave(x, n, dim=axis))(v_cache[:, :, Sk - W:, :], rep, axis=1)
    scores = torch.einsum("bhqd,bhkd->bhqk", q, k) * (Dh ** -0.5)
    p = _softmax(scores, axis=-1)
    o = torch.einsum("bhqk,bhkd->bhqd", p, v)
    return (lambda x, *d: x.permute(*d))(o, 0, 2, 1, 3).reshape(B, Sq, Hq * Dh) @ wo
```

```asm
; @launch grid=(256,1,1) block=(256,1,1) lds=163840
.amdgcn_target "amdgcn-amd-amdhsa--gfx950"
.text
.globl standalone__sliding_block_cached__sampling_kernel
.p2align 8
.type standalone__sliding_block_cached__sampling_kernel,@function
standalone__sliding_block_cached__sampling_kernel:
  s_cmp_ge_u32 s2, 256
  s_cbranch_scc1 L_end
  s_load_dwordx16 s[80:95], s[0:1], 0
  s_memrealtime s[30:31]
  s_sub_u32 s3, s2, 128
  s_cmp_lt_u32 s3, 256
  s_cbranch_scc0 L_nocw
  s_getpc_b64 s[44:45]
L_pc:
  s_sub_u32 s44, s44, L_pc-standalone__sliding_block_cached__sampling_kernel
  s_subb_u32 s45, s45, 0
  v_lshlrev_b32 v9, 7, v0
  v_min_u32 v9, L_code_end-standalone__sliding_block_cached__sampling_kernel-4, v9
  global_load_dword v25, v9, s[44:45]
L_nocw:
  s_lshr_b32 s3, s2, 7
  s_xor_b32 s2, s2, s3
  v_lshrrev_b32 v8, 6, v0
  v_and_b32 v252, 63, v0
  v_readfirstlane_b32 s32, v8
  v_lshrrev_b32 v253, 4, v252
  v_and_b32 v254, 15, v252
  s_and_b32 s33, s2, 7
  s_lshl_b32 s33, s33, 1
  s_bfe_u32 s34, s2, 0x10003
  s_add_u32 s33, s33, s34
  s_bfe_u32 s34, s2, 0x30004
  s_and_b32 s35, s2, 127
  s_lshl_b32 s44, s34, 25
  s_lshl_b32 s45, s33, 21
  s_add_u32 s44, s44, s45
  s_add_u32 s44, s44, 1572864
  s_add_u32 s45, s44, 278528
  s_cmp_ge_u32 s2, 128
  s_cselect_b32 s46, s44, s45
  s_cselect_b32 s53, 17, 15
  s_lshl_b32 s51, s32, 12
  s_add_u32 s47, s51, 81920
  s_and_b32 s101, s32, 1
  v_lshlrev_b32 v1, 4, v252
  s_cmp_lt_u32 s2, 128
  s_cbranch_scc1 L_g2
  v_or_b32 v8, 0, v253
  v_xor_b32 v8, v8, v254
  v_lshlrev_b32 v8, 4, v8
  v_lshl_add_u32 v4, v253, 8, v8
  v_or_b32 v8, 4, v253
  v_xor_b32 v8, v8, v254
  v_lshlrev_b32 v8, 4, v8
  v_lshl_add_u32 v5, v253, 8, v8
  v_or_b32 v8, 8, v253
  v_xor_b32 v8, v8, v254
  v_lshlrev_b32 v8, 4, v8
  v_lshl_add_u32 v6, v253, 8, v8
  v_or_b32 v8, 12, v253
  v_xor_b32 v8, v8, v254
  v_lshlrev_b32 v8, 4, v8
  v_lshl_add_u32 v7, v253, 8, v8
  v_lshlrev_b32 v8, 2, v253
  v_xor_b32 v8, v8, v254
  v_lshlrev_b32 v8, 4, v8
  v_lshl_add_u32 v2, v253, 8, v8
  s_mov_b32 s41, 0x3e0293ee
  s_mov_b32 s98, 0x427af233
  s_mov_b32 s42, 0x05040100
  s_mov_b32 s43, 0x07060302
  s_mov_b32 s99, 16384
  s_mov_b32 s24, 0x1000000
  s_mov_b32 s25, 0
  v_and_b32 v8, 31, v252
  v_lshlrev_b32 v8, 8, v8
  v_mov_b32 v9, s101
  v_lshl_add_u32 v8, v9, 13, v8
  v_lshrrev_b32 v10, 5, v252
  v_xor_b32 v10, v10, v254
  v_xor_b32 v11, 0, v10
  v_lshl_add_u32 v12, v11, 4, v8
  v_xor_b32 v11, 2, v10
  v_lshl_add_u32 v13, v11, 4, v8
  v_xor_b32 v11, 4, v10
  v_lshl_add_u32 v14, v11, 4, v8
  v_xor_b32 v11, 6, v10
  v_lshl_add_u32 v15, v11, 4, v8
  v_xor_b32 v11, 8, v10
  v_lshl_add_u32 v16, v11, 4, v8
  v_xor_b32 v11, 10, v10
  v_lshl_add_u32 v17, v11, 4, v8
  v_xor_b32 v11, 12, v10
  v_lshl_add_u32 v18, v11, 4, v8
  v_xor_b32 v11, 14, v10
  v_lshl_add_u32 v19, v11, 4, v8
  v_lshrrev_b32 v10, 2, v254
  v_lshrrev_b32 v8, 5, v252
  v_lshl_add_u32 v8, v8, 2, v10
  v_lshlrev_b32 v8, 8, v8
  v_lshl_add_u32 v8, v9, 13, v8
  v_and_b32 v11, 3, v254
  v_lshl_add_u32 v8, v11, 3, v8
  v_and_b32 v11, 1, v253
  v_lshl_add_u32 v8, v11, 5, v8
  v_add_u32 v8, 98304, v8
  v_lshlrev_b32 v9, 1, v9
  v_xor_b32 v10, v10, v9
  v_xor_b32 v11, 0, v10
  v_lshl_add_u32 v20, v11, 6, v8
  v_xor_b32 v11, 1, v10
  v_lshl_add_u32 v21, v11, 6, v8
  v_xor_b32 v11, 2, v10
  v_lshl_add_u32 v22, v11, 6, v8
  v_xor_b32 v11, 3, v10
  v_lshl_add_u32 v23, v11, 6, v8
  v_lshrrev_b32 v8, 2, v254
  v_xor_b32 v8, v8, v253
  v_and_b32 v8, 1, v8
  v_add_u32 v8, -1, v8
  v_and_b32 v28, 0x3f803f80, v8
  v_mov_b32 v29, v28
  v_mov_b32 v30, v28
  v_mov_b32 v31, v28
  s_mul_i32 s50, s33, 294912
  s_mul_i32 s44, s34, 36864
  s_mul_i32 s45, s32, 9216
  s_add_u32 s44, s44, s45
  s_add_u32 s44, s44, s50
  v_lshlrev_b32 v8, 7, v252
  s_waitcnt lgkmcnt(0)
  s_mov_b32 s16, s88
  s_and_b32 s17, s89, 0xffff
  s_mov_b32 s18, 0x480000
  s_mov_b32 s19, 0x20000
  buffer_load_dword v26, v8, s[16:19], s44 offen
  buffer_load_dword v27, v8, s[16:19], s44 offen offset:1024
  s_add_u32 s4, s82, s46
  s_addc_u32 s5, s83, 0
  s_and_b32 s5, s5, 0xffff
  s_lshl_b32 s6, s53, 14
  s_mov_b32 s7, 0x20000
  s_sub_u32 s46, s46, 16384
  s_add_u32 s8, s84, s46
  s_addc_u32 s9, s85, 0
  s_and_b32 s9, s9, 0xffff
  s_add_u32 s10, s6, 16384
  s_mov_b32 s11, 0x20000
  s_mov_b32 s36, s51
  s_mov_b32 s38, s51
  s_mov_b32 m0, s38
  s_add_u32 s39, s38, 16384
  buffer_load_dwordx4 v4, s[4:7], s36 offen offset:0 nt lds
  buffer_load_dwordx4 v5, s[4:7], s36 offen offset:1024 nt lds
  buffer_load_dwordx4 v6, s[4:7], s36 offen offset:2048 nt lds
  buffer_load_dwordx4 v7, s[4:7], s36 offen offset:3072 nt lds
  s_cmp_ge_u32 s39, s47
  s_cselect_b32 s38, s51, s39
  s_add_u32 m0, s38, 81920
  s_nop 0
  s_add_u32 s36, s36, 16384
  s_mov_b32 m0, s38
  s_add_u32 s39, s38, 16384
  buffer_load_dwordx4 v4, s[4:7], s36 offen offset:0 nt lds
  buffer_load_dwordx4 v5, s[4:7], s36 offen offset:1024 nt lds
  buffer_load_dwordx4 v6, s[4:7], s36 offen offset:2048 nt lds
  buffer_load_dwordx4 v7, s[4:7], s36 offen offset:3072 nt lds
  s_cmp_ge_u32 s39, s47
  s_cselect_b32 s38, s51, s39
  s_add_u32 m0, s38, 81920
  s_nop 0
  buffer_load_dwordx4 v2, s[8:11], s36 offen offset:0 nt lds
  buffer_load_dwordx4 v2, s[8:11], s36 offen offset:1024 nt lds
  buffer_load_dwordx4 v2, s[8:11], s36 offen offset:2048 nt lds
  buffer_load_dwordx4 v2, s[8:11], s36 offen offset:3072 nt lds
  s_add_u32 s36, s36, 16384
  s_mov_b32 s20, s94
  s_and_b32 s21, s95, 0xffff
  s_mov_b32 s22, 0x40000000
  s_mov_b32 s23, 0x20000
  s_and_b32 s93, s93, 0xffff
  s_mov_b32 s94, 256
  s_mov_b32 s95, 0x20000
  s_cmp_eq_u32 s32, 3
  s_cbranch_scc0 L_noepa
  s_not_b64 s[44:45], s[30:31]
  v_mov_b32 v8, s44
  v_mov_b32 v9, s45
  s_lshl_b32 s44, s34, 5
  s_mov_b64 exec, 1
  buffer_atomic_umax_x2 v[8:9], off, s[92:95], s44 sc1
  s_mov_b64 exec, -1
L_noepa:
  v_lshrrev_b32 v8, 1, v253
  v_lshlrev_b32 v8, 2, v8
  v_and_b32 v9, 1, v253
  v_add_u32 v8, v8, v9
  v_mul_u32_u24 v8, 4608, v8
  s_lshl_b32 s44, s32, 8
  v_lshl_add_u32 v68, v254, 4, v8
  v_add_u32 v68, s44, v68
  v_add_u32 v69, 9216, v68
  s_mov_b32 m0, s38
  s_add_u32 s39, s38, 16384
  buffer_load_dwordx4 v4, s[4:7], s36 offen offset:0 nt lds
  buffer_load_dwordx4 v5, s[4:7], s36 offen offset:1024 nt lds
  buffer_load_dwordx4 v6, s[4:7], s36 offen offset:2048 nt lds
  buffer_load_dwordx4 v7, s[4:7], s36 offen offset:3072 nt lds
  s_cmp_ge_u32 s39, s47
  s_cselect_b32 s38, s51, s39
  s_add_u32 m0, s38, 81920
  s_nop 0
  buffer_load_dwordx4 v2, s[8:11], s36 offen offset:0 nt lds
  buffer_load_dwordx4 v2, s[8:11], s36 offen offset:1024 nt lds
  buffer_load_dwordx4 v2, s[8:11], s36 offen offset:2048 nt lds
  buffer_load_dwordx4 v2, s[8:11], s36 offen offset:3072 nt lds
  s_add_u32 s36, s36, 16384
  s_mov_b32 m0, s38
  s_add_u32 s39, s38, 16384
  buffer_load_dwordx4 v4, s[4:7], s36 offen offset:0 nt lds
  buffer_load_dwordx4 v5, s[4:7], s36 offen offset:1024 nt lds
  buffer_load_dwordx4 v6, s[4:7], s36 offen offset:2048 nt lds
  buffer_load_dwordx4 v7, s[4:7], s36 offen offset:3072 nt lds
  s_cmp_ge_u32 s39, s47
  s_cselect_b32 s38, s51, s39
  s_add_u32 m0, s38, 81920
  s_nop 0
  buffer_load_dwordx4 v2, s[8:11], s36 offen offset:0 nt lds
  buffer_load_dwordx4 v2, s[8:11], s36 offen offset:1024 nt lds
  buffer_load_dwordx4 v2, s[8:11], s36 offen offset:2048 nt lds
  buffer_load_dwordx4 v2, s[8:11], s36 offen offset:3072 nt lds
  s_add_u32 s36, s36, 16384
  s_mov_b32 m0, s38
  s_add_u32 s39, s38, 16384
  buffer_load_dwordx4 v4, s[4:7], s36 offen offset:0 nt lds
  buffer_load_dwordx4 v5, s[4:7], s36 offen offset:1024 nt lds
  buffer_load_dwordx4 v6, s[4:7], s36 offen offset:2048 nt lds
  buffer_load_dwordx4 v7, s[4:7], s36 offen offset:3072 nt lds
  s_cmp_ge_u32 s39, s47
  s_cselect_b32 s38, s51, s39
  s_add_u32 m0, s38, 81920
  s_nop 0
  buffer_load_dwordx4 v2, s[8:11], s36 offen offset:0 nt lds
  buffer_load_dwordx4 v2, s[8:11], s36 offen offset:1024 nt lds
  buffer_load_dwordx4 v2, s[8:11], s36 offen offset:2048 nt lds
  buffer_load_dwordx4 v2, s[8:11], s36 offen offset:3072 nt lds
  s_add_u32 s36, s36, 16384
  s_lshl_b32 s44, s35, 2
  s_add_u32 s44, s44, s32
  s_mul_i32 s52, s44, 6144
  s_add_u32 s49, s52, 4096
  s_sub_u32 s26, s30, 500
  s_subb_u32 s27, s31, 0
  s_add_u32 s46, s50, 0
  buffer_load_dwordx4 v[88:91], v68, s[16:19], s46 offen offset:0
  buffer_load_dwordx4 v[92:95], v68, s[16:19], s46 offen offset:1152
  buffer_load_dwordx4 v[96:99], v68, s[16:19], s46 offen offset:2304
  buffer_load_dwordx4 v[100:103], v68, s[16:19], s46 offen offset:3456
  buffer_load_dwordx4 v[104:107], v69, s[16:19], s46 offen offset:0
  buffer_load_dwordx4 v[108:111], v69, s[16:19], s46 offen offset:1152
  buffer_load_dwordx4 v[112:115], v69, s[16:19], s46 offen offset:2304
  buffer_load_dwordx4 v[116:119], v69, s[16:19], s46 offen offset:3456
  s_add_u32 s46, s50, 36864
  buffer_load_dwordx4 v[120:123], v68, s[16:19], s46 offen offset:0
  buffer_load_dwordx4 v[124:127], v68, s[16:19], s46 offen offset:1152
  buffer_load_dwordx4 v[128:131], v68, s[16:19], s46 offen offset:2304
  buffer_load_dwordx4 v[132:135], v68, s[16:19], s46 offen offset:3456
  buffer_load_dwordx4 v[136:139], v69, s[16:19], s46 offen offset:0
  buffer_load_dwordx4 v[140:143], v69, s[16:19], s46 offen offset:1152
  buffer_load_dwordx4 v[144:147], v69, s[16:19], s46 offen offset:2304
  buffer_load_dwordx4 v[148:151], v69, s[16:19], s46 offen offset:3456
  s_waitcnt vmcnt(40)
  s_add_u32 s46, s50, 73728
  buffer_load_dwordx4 v[152:155], v68, s[16:19], s46 offen offset:0
  buffer_load_dwordx4 v[156:159], v68, s[16:19], s46 offen offset:1152
  buffer_load_dwordx4 v[160:163], v68, s[16:19], s46 offen offset:2304
  buffer_load_dwordx4 v[164:167], v68, s[16:19], s46 offen offset:3456
  buffer_load_dwordx4 v[168:171], v69, s[16:19], s46 offen offset:0
  buffer_load_dwordx4 v[172:175], v69, s[16:19], s46 offen offset:1152
  buffer_load_dwordx4 v[176:179], v69, s[16:19], s46 offen offset:2304
  buffer_load_dwordx4 v[180:183], v69, s[16:19], s46 offen offset:3456
  s_add_u32 s46, s50, 110592
  buffer_load_dwordx4 v[184:187], v68, s[16:19], s46 offen offset:0
  buffer_load_dwordx4 v[188:191], v68, s[16:19], s46 offen offset:1152
  buffer_load_dwordx4 v[192:195], v68, s[16:19], s46 offen offset:2304
  buffer_load_dwordx4 v[196:199], v68, s[16:19], s46 offen offset:3456
  buffer_load_dwordx4 v[200:203], v69, s[16:19], s46 offen offset:0
  buffer_load_dwordx4 v[204:207], v69, s[16:19], s46 offen offset:1152
  buffer_load_dwordx4 v[208:211], v69, s[16:19], s46 offen offset:2304
  buffer_load_dwordx4 v[212:215], v69, s[16:19], s46 offen offset:3456
  s_waitcnt vmcnt(24)
  v_perm_b32 v72, v92, v88, s42
  v_accvgpr_write_b32 a0, v72
  v_perm_b32 v73, v100, v96, s42
  v_accvgpr_write_b32 a1, v73
  v_perm_b32 v74, v108, v104, s42
  v_accvgpr_write_b32 a2, v74
  v_perm_b32 v75, v116, v112, s42
  v_accvgpr_write_b32 a3, v75
  s_add_u32 s46, s50, 147456
  v_perm_b32 v76, v92, v88, s43
  v_accvgpr_write_b32 a4, v76
  v_perm_b32 v77, v100, v96, s43
  v_accvgpr_write_b32 a5, v77
  v_perm_b32 v78, v108, v104, s43
  v_accvgpr_write_b32 a6, v78
  v_perm_b32 v79, v116, v112, s43
  buffer_load_dwordx4 v[216:219], v68, s[16:19], s46 offen offset:0
  v_accvgpr_write_b32 a7, v79
  v_perm_b32 v72, v93, v89, s42
  v_accvgpr_write_b32 a8, v72
  v_perm_b32 v73, v101, v97, s42
  v_accvgpr_write_b32 a9, v73
  v_perm_b32 v74, v109, v105, s42
  v_accvgpr_write_b32 a10, v74
  buffer_load_dwordx4 v[220:223], v68, s[16:19], s46 offen offset:1152
  v_perm_b32 v75, v117, v113, s42
  v_accvgpr_write_b32 a11, v75
  v_perm_b32 v76, v93, v89, s43
  v_accvgpr_write_b32 a12, v76
  v_perm_b32 v77, v101, v97, s43
  v_accvgpr_write_b32 a13, v77
  v_perm_b32 v78, v109, v105, s43
  buffer_load_dwordx4 v[224:227], v68, s[16:19], s46 offen offset:2304
  v_accvgpr_write_b32 a14, v78
  v_perm_b32 v79, v117, v113, s43
  v_accvgpr_write_b32 a15, v79
  v_perm_b32 v72, v94, v90, s42
  v_accvgpr_write_b32 a16, v72
  v_perm_b32 v73, v102, v98, s42
  v_accvgpr_write_b32 a17, v73
  buffer_load_dwordx4 v[228:231], v68, s[16:19], s46 offen offset:3456
  v_perm_b32 v74, v110, v106, s42
  v_accvgpr_write_b32 a18, v74
  v_perm_b32 v75, v118, v114, s42
  v_accvgpr_write_b32 a19, v75
  v_perm_b32 v76, v94, v90, s43
  v_accvgpr_write_b32 a20, v76
  v_perm_b32 v77, v102, v98, s43
  buffer_load_dwordx4 v[232:235], v69, s[16:19], s46 offen offset:0
  v_accvgpr_write_b32 a21, v77
  v_perm_b32 v78, v110, v106, s43
  v_accvgpr_write_b32 a22, v78
  v_perm_b32 v79, v118, v114, s43
  v_accvgpr_write_b32 a23, v79
  v_perm_b32 v72, v95, v91, s42
  v_accvgpr_write_b32 a24, v72
  buffer_load_dwordx4 v[236:239], v69, s[16:19], s46 offen offset:1152
  v_perm_b32 v73, v103, v99, s42
  v_accvgpr_write_b32 a25, v73
  v_perm_b32 v74, v111, v107, s42
  v_accvgpr_write_b32 a26, v74
  v_perm_b32 v75, v119, v115, s42
  v_accvgpr_write_b32 a27, v75
  v_perm_b32 v76, v95, v91, s43
  buffer_load_dwordx4 v[240:243], v69, s[16:19], s46 offen offset:2304
  v_accvgpr_write_b32 a28, v76
  v_perm_b32 v77, v103, v99, s43
  v_accvgpr_write_b32 a29, v77
  v_perm_b32 v78, v111, v107, s43
  v_accvgpr_write_b32 a30, v78
  v_perm_b32 v79, v119, v115, s43
  v_accvgpr_write_b32 a31, v79
  buffer_load_dwordx4 v[244:247], v69, s[16:19], s46 offen offset:3456
  s_waitcnt vmcnt(24)
  v_perm_b32 v72, v124, v120, s42
  v_accvgpr_write_b32 a32, v72
  v_perm_b32 v73, v132, v128, s42
  v_accvgpr_write_b32 a33, v73
  v_perm_b32 v74, v140, v136, s42
  v_accvgpr_write_b32 a34, v74
  v_perm_b32 v75, v148, v144, s42
  v_accvgpr_write_b32 a35, v75
  s_add_u32 s46, s50, 184320
  v_perm_b32 v76, v124, v120, s43
  v_accvgpr_write_b32 a36, v76
  v_perm_b32 v77, v132, v128, s43
  v_accvgpr_write_b32 a37, v77
  v_perm_b32 v78, v140, v136, s43
  v_accvgpr_write_b32 a38, v78
  v_perm_b32 v79, v148, v144, s43
  buffer_load_dwordx4 v[88:91], v68, s[16:19], s46 offen offset:0
  v_accvgpr_write_b32 a39, v79
  v_perm_b32 v72, v125, v121, s42
  v_accvgpr_write_b32 a40, v72
  v_perm_b32 v73, v133, v129, s42
  v_accvgpr_write_b32 a41, v73
  v_perm_b32 v74, v141, v137, s42
  v_accvgpr_write_b32 a42, v74
  buffer_load_dwordx4 v[92:95], v68, s[16:19], s46 offen offset:1152
  v_perm_b32 v75, v149, v145, s42
  v_accvgpr_write_b32 a43, v75
  v_perm_b32 v76, v125, v121, s43
  v_accvgpr_write_b32 a44, v76
  v_perm_b32 v77, v133, v129, s43
  v_accvgpr_write_b32 a45, v77
  v_perm_b32 v78, v141, v137, s43
  buffer_load_dwordx4 v[96:99], v68, s[16:19], s46 offen offset:2304
  v_accvgpr_write_b32 a46, v78
  v_perm_b32 v79, v149, v145, s43
  v_accvgpr_write_b32 a47, v79
  v_perm_b32 v72, v126, v122, s42
  v_accvgpr_write_b32 a48, v72
  v_perm_b32 v73, v134, v130, s42
  v_accvgpr_write_b32 a49, v73
  buffer_load_dwordx4 v[100:103], v68, s[16:19], s46 offen offset:3456
  v_perm_b32 v74, v142, v138, s42
  v_accvgpr_write_b32 a50, v74
  v_perm_b32 v75, v150, v146, s42
  v_accvgpr_write_b32 a51, v75
  v_perm_b32 v76, v126, v122, s43
  v_accvgpr_write_b32 a52, v76
  v_perm_b32 v77, v134, v130, s43
  buffer_load_dwordx4 v[104:107], v69, s[16:19], s46 offen offset:0
  v_accvgpr_write_b32 a53, v77
  v_perm_b32 v78, v142, v138, s43
  v_accvgpr_write_b32 a54, v78
  v_perm_b32 v79, v150, v146, s43
  v_accvgpr_write_b32 a55, v79
  v_perm_b32 v72, v127, v123, s42
  v_accvgpr_write_b32 a56, v72
  buffer_load_dwordx4 v[108:111], v69, s[16:19], s46 offen offset:1152
  v_perm_b32 v73, v135, v131, s42
  v_accvgpr_write_b32 a57, v73
  v_perm_b32 v74, v143, v139, s42
  v_accvgpr_write_b32 a58, v74
  v_perm_b32 v75, v151, v147, s42
  v_accvgpr_write_b32 a59, v75
  v_perm_b32 v76, v127, v123, s43
  buffer_load_dwordx4 v[112:115], v69, s[16:19], s46 offen offset:2304
  v_accvgpr_write_b32 a60, v76
  v_perm_b32 v77, v135, v131, s43
  v_accvgpr_write_b32 a61, v77
  v_perm_b32 v78, v143, v139, s43
  v_accvgpr_write_b32 a62, v78
  v_perm_b32 v79, v151, v147, s43
  v_accvgpr_write_b32 a63, v79
  buffer_load_dwordx4 v[116:119], v69, s[16:19], s46 offen offset:3456
  s_waitcnt vmcnt(24)
  v_perm_b32 v72, v156, v152, s42
  v_accvgpr_write_b32 a64, v72
  v_perm_b32 v73, v164, v160, s42
  v_accvgpr_write_b32 a65, v73
  v_perm_b32 v74, v172, v168, s42
  v_accvgpr_write_b32 a66, v74
  v_perm_b32 v75, v180, v176, s42
  v_accvgpr_write_b32 a67, v75
  s_add_u32 s46, s50, 221184
  v_perm_b32 v76, v156, v152, s43
  v_accvgpr_write_b32 a68, v76
  v_perm_b32 v77, v164, v160, s43
  v_accvgpr_write_b32 a69, v77
  v_perm_b32 v78, v172, v168, s43
  v_accvgpr_write_b32 a70, v78
  v_perm_b32 v79, v180, v176, s43
  buffer_load_dwordx4 v[120:123], v68, s[16:19], s46 offen offset:0
  v_accvgpr_write_b32 a71, v79
  v_perm_b32 v72, v157, v153, s42
  v_accvgpr_write_b32 a72, v72
  v_perm_b32 v73, v165, v161, s42
  v_accvgpr_write_b32 a73, v73
  v_perm_b32 v74, v173, v169, s42
  v_accvgpr_write_b32 a74, v74
  buffer_load_dwordx4 v[124:127], v68, s[16:19], s46 offen offset:1152
  v_perm_b32 v75, v181, v177, s42
  v_accvgpr_write_b32 a75, v75
  v_perm_b32 v76, v157, v153, s43
  v_accvgpr_write_b32 a76, v76
  v_perm_b32 v77, v165, v161, s43
  v_accvgpr_write_b32 a77, v77
  v_perm_b32 v78, v173, v169, s43
  buffer_load_dwordx4 v[128:131], v68, s[16:19], s46 offen offset:2304
  v_accvgpr_write_b32 a78, v78
  v_perm_b32 v79, v181, v177, s43
  v_accvgpr_write_b32 a79, v79
  v_perm_b32 v72, v158, v154, s42
  v_accvgpr_write_b32 a80, v72
  v_perm_b32 v73, v166, v162, s42
  v_accvgpr_write_b32 a81, v73
  buffer_load_dwordx4 v[132:135], v68, s[16:19], s46 offen offset:3456
  v_perm_b32 v74, v174, v170, s42
  v_accvgpr_write_b32 a82, v74
  v_perm_b32 v75, v182, v178, s42
  v_accvgpr_write_b32 a83, v75
  v_perm_b32 v76, v158, v154, s43
  v_accvgpr_write_b32 a84, v76
  v_perm_b32 v77, v166, v162, s43
  buffer_load_dwordx4 v[136:139], v69, s[16:19], s46 offen offset:0
  v_accvgpr_write_b32 a85, v77
  v_perm_b32 v78, v174, v170, s43
  v_accvgpr_write_b32 a86, v78
  v_perm_b32 v79, v182, v178, s43
  v_accvgpr_write_b32 a87, v79
  v_perm_b32 v72, v159, v155, s42
  v_accvgpr_write_b32 a88, v72
  buffer_load_dwordx4 v[140:143], v69, s[16:19], s46 offen offset:1152
  v_perm_b32 v73, v167, v163, s42
  v_accvgpr_write_b32 a89, v73
  v_perm_b32 v74, v175, v171, s42
  v_accvgpr_write_b32 a90, v74
  v_perm_b32 v75, v183, v179, s42
  v_accvgpr_write_b32 a91, v75
  v_perm_b32 v76, v159, v155, s43
  buffer_load_dwordx4 v[144:147], v69, s[16:19], s46 offen offset:2304
  v_accvgpr_write_b32 a92, v76
  v_perm_b32 v77, v167, v163, s43
  v_accvgpr_write_b32 a93, v77
  v_perm_b32 v78, v175, v171, s43
  v_accvgpr_write_b32 a94, v78
  v_perm_b32 v79, v183, v179, s43
  v_accvgpr_write_b32 a95, v79
  buffer_load_dwordx4 v[148:151], v69, s[16:19], s46 offen offset:3456
  s_waitcnt vmcnt(24)
  v_perm_b32 v72, v188, v184, s42
  v_accvgpr_write_b32 a96, v72
  v_perm_b32 v73, v196, v192, s42
  v_accvgpr_write_b32 a97, v73
  v_perm_b32 v74, v204, v200, s42
  v_accvgpr_write_b32 a98, v74
  v_perm_b32 v75, v212, v208, s42
  v_accvgpr_write_b32 a99, v75
  s_add_u32 s46, s50, 258048
  v_perm_b32 v76, v188, v184, s43
  v_accvgpr_write_b32 a100, v76
  v_perm_b32 v77, v196, v192, s43
  v_accvgpr_write_b32 a101, v77
  v_perm_b32 v78, v204, v200, s43
  v_accvgpr_write_b32 a102, v78
  v_perm_b32 v79, v212, v208, s43
  buffer_load_dwordx4 v[152:155], v68, s[16:19], s46 offen offset:0
  v_accvgpr_write_b32 a103, v79
  v_perm_b32 v72, v189, v185, s42
  v_accvgpr_write_b32 a104, v72
  v_perm_b32 v73, v197, v193, s42
  v_accvgpr_write_b32 a105, v73
  v_perm_b32 v74, v205, v201, s42
  v_accvgpr_write_b32 a106, v74
  buffer_load_dwordx4 v[156:159], v68, s[16:19], s46 offen offset:1152
  v_perm_b32 v75, v213, v209, s42
  v_accvgpr_write_b32 a107, v75
  v_perm_b32 v76, v189, v185, s43
  v_accvgpr_write_b32 a108, v76
  v_perm_b32 v77, v197, v193, s43
  v_accvgpr_write_b32 a109, v77
  v_perm_b32 v78, v205, v201, s43
  buffer_load_dwordx4 v[160:163], v68, s[16:19], s46 offen offset:2304
  v_accvgpr_write_b32 a110, v78
  v_perm_b32 v79, v213, v209, s43
  v_accvgpr_write_b32 a111, v79
  v_perm_b32 v72, v190, v186, s42
  v_accvgpr_write_b32 a112, v72
  v_perm_b32 v73, v198, v194, s42
  v_accvgpr_write_b32 a113, v73
  buffer_load_dwordx4 v[164:167], v68, s[16:19], s46 offen offset:3456
  v_perm_b32 v74, v206, v202, s42
  v_accvgpr_write_b32 a114, v74
  v_perm_b32 v75, v214, v210, s42
  v_accvgpr_write_b32 a115, v75
  v_perm_b32 v76, v190, v186, s43
  v_accvgpr_write_b32 a116, v76
  v_perm_b32 v77, v198, v194, s43
  buffer_load_dwordx4 v[168:171], v69, s[16:19], s46 offen offset:0
  v_accvgpr_write_b32 a117, v77
  v_perm_b32 v78, v206, v202, s43
  v_accvgpr_write_b32 a118, v78
  v_perm_b32 v79, v214, v210, s43
  v_accvgpr_write_b32 a119, v79
  v_perm_b32 v72, v191, v187, s42
  v_accvgpr_write_b32 a120, v72
  buffer_load_dwordx4 v[172:175], v69, s[16:19], s46 offen offset:1152
  v_perm_b32 v73, v199, v195, s42
  v_accvgpr_write_b32 a121, v73
  v_perm_b32 v74, v207, v203, s42
  v_accvgpr_write_b32 a122, v74
  v_perm_b32 v75, v215, v211, s42
  v_accvgpr_write_b32 a123, v75
  v_perm_b32 v76, v191, v187, s43
  buffer_load_dwordx4 v[176:179], v69, s[16:19], s46 offen offset:2304
  v_accvgpr_write_b32 a124, v76
  v_perm_b32 v77, v199, v195, s43
  v_accvgpr_write_b32 a125, v77
  v_perm_b32 v78, v207, v203, s43
  v_accvgpr_write_b32 a126, v78
  v_perm_b32 v79, v215, v211, s43
  v_accvgpr_write_b32 a127, v79
  buffer_load_dwordx4 v[180:183], v69, s[16:19], s46 offen offset:3456
  s_waitcnt vmcnt(24)
  v_perm_b32 v72, v220, v216, s42
  v_accvgpr_write_b32 a128, v72
  v_perm_b32 v73, v228, v224, s42
  v_accvgpr_write_b32 a129, v73
  v_perm_b32 v74, v236, v232, s42
  v_accvgpr_write_b32 a130, v74
  v_perm_b32 v75, v244, v240, s42
  v_accvgpr_write_b32 a131, v75
  v_perm_b32 v76, v220, v216, s43
  v_accvgpr_write_b32 a132, v76
  v_perm_b32 v77, v228, v224, s43
  v_accvgpr_write_b32 a133, v77
  v_perm_b32 v78, v236, v232, s43
  v_accvgpr_write_b32 a134, v78
  v_perm_b32 v79, v244, v240, s43
  v_accvgpr_write_b32 a135, v79
  v_perm_b32 v72, v221, v217, s42
  v_accvgpr_write_b32 a136, v72
  v_perm_b32 v73, v229, v225, s42
  v_accvgpr_write_b32 a137, v73
  v_perm_b32 v74, v237, v233, s42
  v_accvgpr_write_b32 a138, v74
  v_perm_b32 v75, v245, v241, s42
  v_accvgpr_write_b32 a139, v75
  v_perm_b32 v76, v221, v217, s43
  v_accvgpr_write_b32 a140, v76
  v_perm_b32 v77, v229, v225, s43
  v_accvgpr_write_b32 a141, v77
  v_perm_b32 v78, v237, v233, s43
  v_accvgpr_write_b32 a142, v78
  v_perm_b32 v79, v245, v241, s43
  v_accvgpr_write_b32 a143, v79
  v_perm_b32 v72, v222, v218, s42
  v_accvgpr_write_b32 a144, v72
  v_perm_b32 v73, v230, v226, s42
  v_accvgpr_write_b32 a145, v73
  v_perm_b32 v74, v238, v234, s42
  v_accvgpr_write_b32 a146, v74
  v_perm_b32 v75, v246, v242, s42
  v_accvgpr_write_b32 a147, v75
  v_perm_b32 v76, v222, v218, s43
  v_accvgpr_write_b32 a148, v76
  v_perm_b32 v77, v230, v226, s43
  v_accvgpr_write_b32 a149, v77
  v_perm_b32 v78, v238, v234, s43
  v_accvgpr_write_b32 a150, v78
  v_perm_b32 v79, v246, v242, s43
  v_accvgpr_write_b32 a151, v79
  v_perm_b32 v72, v223, v219, s42
  v_accvgpr_write_b32 a152, v72
  v_perm_b32 v73, v231, v227, s42
  v_accvgpr_write_b32 a153, v73
  v_perm_b32 v74, v239, v235, s42
  v_accvgpr_write_b32 a154, v74
  v_perm_b32 v75, v247, v243, s42
  v_accvgpr_write_b32 a155, v75
  v_perm_b32 v76, v223, v219, s43
  v_accvgpr_write_b32 a156, v76
  v_perm_b32 v77, v231, v227, s43
  v_accvgpr_write_b32 a157, v77
  v_perm_b32 v78, v239, v235, s43
  v_accvgpr_write_b32 a158, v78
  v_perm_b32 v79, v247, v243, s43
  v_accvgpr_write_b32 a159, v79
  s_waitcnt vmcnt(16)
  v_perm_b32 v72, v92, v88, s42
  v_accvgpr_write_b32 a160, v72
  v_perm_b32 v73, v100, v96, s42
  v_accvgpr_write_b32 a161, v73
  v_perm_b32 v74, v108, v104, s42
  v_accvgpr_write_b32 a162, v74
  v_perm_b32 v75, v116, v112, s42
  v_accvgpr_write_b32 a163, v75
  v_perm_b32 v76, v92, v88, s43
  v_accvgpr_write_b32 a164, v76
  v_perm_b32 v77, v100, v96, s43
  v_accvgpr_write_b32 a165, v77
  v_perm_b32 v78, v108, v104, s43
  v_accvgpr_write_b32 a166, v78
  v_perm_b32 v79, v116, v112, s43
  v_accvgpr_write_b32 a167, v79
  v_perm_b32 v72, v93, v89, s42
  v_accvgpr_write_b32 a168, v72
  v_perm_b32 v73, v101, v97, s42
  v_accvgpr_write_b32 a169, v73
  v_perm_b32 v74, v109, v105, s42
  v_accvgpr_write_b32 a170, v74
  v_perm_b32 v75, v117, v113, s42
  v_accvgpr_write_b32 a171, v75
  v_perm_b32 v76, v93, v89, s43
  v_accvgpr_write_b32 a172, v76
  v_perm_b32 v77, v101, v97, s43
  v_accvgpr_write_b32 a173, v77
  v_perm_b32 v78, v109, v105, s43
  v_accvgpr_write_b32 a174, v78
  v_perm_b32 v79, v117, v113, s43
  v_accvgpr_write_b32 a175, v79
  v_perm_b32 v72, v94, v90, s42
  v_accvgpr_write_b32 a176, v72
  v_perm_b32 v73, v102, v98, s42
  v_accvgpr_write_b32 a177, v73
  v_perm_b32 v74, v110, v106, s42
  v_accvgpr_write_b32 a178, v74
  v_perm_b32 v75, v118, v114, s42
  v_accvgpr_write_b32 a179, v75
  v_perm_b32 v76, v94, v90, s43
  v_accvgpr_write_b32 a180, v76
  v_perm_b32 v77, v102, v98, s43
  v_accvgpr_write_b32 a181, v77
  v_perm_b32 v78, v110, v106, s43
  v_accvgpr_write_b32 a182, v78
  v_perm_b32 v79, v118, v114, s43
  v_accvgpr_write_b32 a183, v79
  v_perm_b32 v72, v95, v91, s42
  v_accvgpr_write_b32 a184, v72
  v_perm_b32 v73, v103, v99, s42
  v_accvgpr_write_b32 a185, v73
  v_perm_b32 v74, v111, v107, s42
  v_accvgpr_write_b32 a186, v74
  v_perm_b32 v75, v119, v115, s42
  v_accvgpr_write_b32 a187, v75
  v_perm_b32 v76, v95, v91, s43
  v_accvgpr_write_b32 a188, v76
  v_perm_b32 v77, v103, v99, s43
  v_accvgpr_write_b32 a189, v77
  v_perm_b32 v78, v111, v107, s43
  v_accvgpr_write_b32 a190, v78
  v_perm_b32 v79, v119, v115, s43
  v_accvgpr_write_b32 a191, v79
  s_waitcnt vmcnt(8)
  v_perm_b32 v72, v124, v120, s42
  v_accvgpr_write_b32 a192, v72
  v_perm_b32 v73, v132, v128, s42
  v_accvgpr_write_b32 a193, v73
  v_perm_b32 v74, v140, v136, s42
  v_accvgpr_write_b32 a194, v74
  v_perm_b32 v75, v148, v144, s42
  v_accvgpr_write_b32 a195, v75
  v_perm_b32 v76, v124, v120, s43
  v_accvgpr_write_b32 a196, v76
  v_perm_b32 v77, v132, v128, s43
  v_accvgpr_write_b32 a197, v77
  v_perm_b32 v78, v140, v136, s43
  v_accvgpr_write_b32 a198, v78
  v_perm_b32 v79, v148, v144, s43
  v_accvgpr_write_b32 a199, v79
  v_perm_b32 v72, v125, v121, s42
  v_accvgpr_write_b32 a200, v72
  v_perm_b32 v73, v133, v129, s42
  v_accvgpr_write_b32 a201, v73
  v_perm_b32 v74, v141, v137, s42
  v_accvgpr_write_b32 a202, v74
  v_perm_b32 v75, v149, v145, s42
  v_accvgpr_write_b32 a203, v75
  v_perm_b32 v76, v125, v121, s43
  v_accvgpr_write_b32 a204, v76
  v_perm_b32 v77, v133, v129, s43
  v_accvgpr_write_b32 a205, v77
  v_perm_b32 v78, v141, v137, s43
  v_accvgpr_write_b32 a206, v78
  v_perm_b32 v79, v149, v145, s43
  v_accvgpr_write_b32 a207, v79
  v_perm_b32 v72, v126, v122, s42
  v_accvgpr_write_b32 a208, v72
  v_perm_b32 v73, v134, v130, s42
  v_accvgpr_write_b32 a209, v73
  v_perm_b32 v74, v142, v138, s42
  v_accvgpr_write_b32 a210, v74
  v_perm_b32 v75, v150, v146, s42
  v_accvgpr_write_b32 a211, v75
  v_perm_b32 v76, v126, v122, s43
  v_accvgpr_write_b32 a212, v76
  v_perm_b32 v77, v134, v130, s43
  v_accvgpr_write_b32 a213, v77
  v_perm_b32 v78, v142, v138, s43
  v_accvgpr_write_b32 a214, v78
  v_perm_b32 v79, v150, v146, s43
  v_accvgpr_write_b32 a215, v79
  v_perm_b32 v72, v127, v123, s42
  v_accvgpr_write_b32 a216, v72
  v_perm_b32 v73, v135, v131, s42
  v_accvgpr_write_b32 a217, v73
  v_perm_b32 v74, v143, v139, s42
  v_accvgpr_write_b32 a218, v74
  v_perm_b32 v75, v151, v147, s42
  v_accvgpr_write_b32 a219, v75
  v_perm_b32 v76, v127, v123, s43
  v_accvgpr_write_b32 a220, v76
  v_perm_b32 v77, v135, v131, s43
  v_accvgpr_write_b32 a221, v77
  v_perm_b32 v78, v143, v139, s43
  v_accvgpr_write_b32 a222, v78
  v_perm_b32 v79, v151, v147, s43
  v_accvgpr_write_b32 a223, v79
  s_waitcnt vmcnt(0)
  v_perm_b32 v72, v156, v152, s42
  v_accvgpr_write_b32 a224, v72
  v_perm_b32 v73, v164, v160, s42
  v_accvgpr_write_b32 a225, v73
  v_perm_b32 v74, v172, v168, s42
  v_accvgpr_write_b32 a226, v74
  v_perm_b32 v75, v180, v176, s42
  v_accvgpr_write_b32 a227, v75
  v_perm_b32 v76, v156, v152, s43
  v_accvgpr_write_b32 a228, v76
  v_perm_b32 v77, v164, v160, s43
  v_accvgpr_write_b32 a229, v77
  v_perm_b32 v78, v172, v168, s43
  v_accvgpr_write_b32 a230, v78
  v_perm_b32 v79, v180, v176, s43
  v_accvgpr_write_b32 a231, v79
  v_perm_b32 v72, v157, v153, s42
  v_accvgpr_write_b32 a232, v72
  v_perm_b32 v73, v165, v161, s42
  v_accvgpr_write_b32 a233, v73
  v_perm_b32 v74, v173, v169, s42
  v_accvgpr_write_b32 a234, v74
  v_perm_b32 v75, v181, v177, s42
  v_accvgpr_write_b32 a235, v75
  v_perm_b32 v76, v157, v153, s43
  v_accvgpr_write_b32 a236, v76
  v_perm_b32 v77, v165, v161, s43
  v_accvgpr_write_b32 a237, v77
  v_perm_b32 v78, v173, v169, s43
  v_accvgpr_write_b32 a238, v78
  v_perm_b32 v79, v181, v177, s43
  v_accvgpr_write_b32 a239, v79
  v_perm_b32 v72, v158, v154, s42
  v_accvgpr_write_b32 a240, v72
  v_perm_b32 v73, v166, v162, s42
  v_accvgpr_write_b32 a241, v73
  v_perm_b32 v74, v174, v170, s42
  v_accvgpr_write_b32 a242, v74
  v_perm_b32 v75, v182, v178, s42
  v_accvgpr_write_b32 a243, v75
  v_perm_b32 v76, v158, v154, s43
  v_accvgpr_write_b32 a244, v76
  v_perm_b32 v77, v166, v162, s43
  v_accvgpr_write_b32 a245, v77
  v_perm_b32 v78, v174, v170, s43
  v_accvgpr_write_b32 a246, v78
  v_perm_b32 v79, v182, v178, s43
  v_accvgpr_write_b32 a247, v79
  v_perm_b32 v72, v159, v155, s42
  v_accvgpr_write_b32 a248, v72
  v_perm_b32 v73, v167, v163, s42
  v_accvgpr_write_b32 a249, v73
  v_perm_b32 v74, v175, v171, s42
  v_accvgpr_write_b32 a250, v74
  v_perm_b32 v75, v183, v179, s42
  v_accvgpr_write_b32 a251, v75
  v_perm_b32 v76, v159, v155, s43
  v_accvgpr_write_b32 a252, v76
  v_perm_b32 v77, v167, v163, s43
  v_accvgpr_write_b32 a253, v77
  v_perm_b32 v78, v175, v171, s43
  v_accvgpr_write_b32 a254, v78
  v_perm_b32 v79, v183, v179, s43
  v_accvgpr_write_b32 a255, v79
  s_mov_b32 s46, 0
  buffer_load_dwordx4 v[36:39], v1, s[20:23], s52 offen offset:0 sc1
  buffer_load_dwordx4 v[40:43], v1, s[20:23], s52 offen offset:1024 sc1
  buffer_load_dwordx4 v[44:47], v1, s[20:23], s52 offen offset:2048 sc1
  buffer_load_dwordx4 v[48:51], v1, s[20:23], s52 offen offset:3072 sc1
  buffer_load_dwordx4 v[52:55], v1, s[20:23], s49 offen offset:0 sc1
  buffer_load_dwordx4 v[56:59], v1, s[20:23], s49 offen offset:1024 sc1
  v_mov_b32 v88, 0
  v_mov_b32 v89, 0
  v_mov_b32 v90, 0
  v_mov_b32 v91, 0
  v_mov_b32 v92, 0
  v_mov_b32 v93, 0
  v_mov_b32 v94, 0
  v_mov_b32 v95, 0
  v_mov_b32 v96, 0
  v_mov_b32 v97, 0
  v_mov_b32 v98, 0
  v_mov_b32 v99, 0
  v_mov_b32 v100, 0
  v_mov_b32 v101, 0
  v_mov_b32 v102, 0
  v_mov_b32 v103, 0
  v_mov_b32 v104, 0
  v_mov_b32 v105, 0
  v_mov_b32 v106, 0
  v_mov_b32 v107, 0
  v_mov_b32 v108, 0
  v_mov_b32 v109, 0
  v_mov_b32 v110, 0
  v_mov_b32 v111, 0
  v_mov_b32 v112, 0
  v_mov_b32 v113, 0
  v_mov_b32 v114, 0
  v_mov_b32 v115, 0
  v_mov_b32 v116, 0
  v_mov_b32 v117, 0
  v_mov_b32 v118, 0
  v_mov_b32 v119, 0
  v_mov_b32 v120, 0
  v_mov_b32 v121, 0
  v_mov_b32 v122, 0
  v_mov_b32 v123, 0
  v_mov_b32 v124, 0
  v_mov_b32 v125, 0
  v_mov_b32 v126, 0
  v_mov_b32 v127, 0
  v_mov_b32 v128, 0
  v_mov_b32 v129, 0
  v_mov_b32 v130, 0
  v_mov_b32 v131, 0
  v_mov_b32 v132, 0
  v_mov_b32 v133, 0
  v_mov_b32 v134, 0
  v_mov_b32 v135, 0
  v_mov_b32 v136, 0
  v_mov_b32 v137, 0
  v_mov_b32 v138, 0
  v_mov_b32 v139, 0
  v_mov_b32 v140, 0
  v_mov_b32 v141, 0
  v_mov_b32 v142, 0
  v_mov_b32 v143, 0
  v_mov_b32 v144, 0
  v_mov_b32 v145, 0
  v_mov_b32 v146, 0
  v_mov_b32 v147, 0
  v_mov_b32 v148, 0
  v_mov_b32 v149, 0
  v_mov_b32 v150, 0
  v_mov_b32 v151, 0
  v_mov_b32 v32, 0
  v_mov_b32 v33, 0
  v_mov_b32 v34, 0
  v_mov_b32 v35, 0
  v_mov_b32 v3, 0xff800000
  v_mov_b32 v24, 0
  v_mov_b32 v168, 0xff800000
  v_mov_b32 v169, 0xff800000
  v_mov_b32 v170, 0xff800000
  v_mov_b32 v171, 0xff800000
  v_mov_b32 v172, 0xff800000
  v_mov_b32 v173, 0xff800000
  v_mov_b32 v174, 0xff800000
  v_mov_b32 v175, 0xff800000
  v_mov_b32 v176, 0xff800000
  v_mov_b32 v177, 0xff800000
  v_mov_b32 v178, 0xff800000
  v_mov_b32 v179, 0xff800000
  v_mov_b32 v180, 0xff800000
  v_mov_b32 v181, 0xff800000
  v_mov_b32 v182, 0xff800000
  v_mov_b32 v183, 0xff800000
  s_mov_b32 s55, 1
  s_mov_b32 s54, 0
  s_mov_b32 s48, 16384
  s_branch L_pollq_chk
L_pollq:
  s_sleep 1
  s_and_b32 s96, s46, 63
  s_cbranch_scc1 L_noelq
  s_lshl_b32 s96, s34, 5
  buffer_load_dwordx2 v[8:9], off, s[92:95], s96 sc1
  s_waitcnt vmcnt(0)
  v_readfirstlane_b32 s96, v8
  v_readfirstlane_b32 s97, v9
  s_nop 1
  s_not_b64 s[96:97], s[96:97]
  s_sub_u32 s3, s96, s26
  s_subb_u32 s3, s97, s27
  s_cselect_b64 s[26:27], s[96:97], s[26:27]
L_noelq:
L_pollq_ld:
  buffer_load_dwordx4 v[36:39], v1, s[20:23], s52 offen offset:0 sc1
  buffer_load_dwordx4 v[40:43], v1, s[20:23], s52 offen offset:1024 sc1
  buffer_load_dwordx4 v[44:47], v1, s[20:23], s52 offen offset:2048 sc1
  buffer_load_dwordx4 v[48:51], v1, s[20:23], s52 offen offset:3072 sc1
  buffer_load_dwordx4 v[52:55], v1, s[20:23], s49 offen offset:0 sc1
  buffer_load_dwordx4 v[56:59], v1, s[20:23], s49 offen offset:1024 sc1
L_pollq_chk:
  v_mov_b32 v11, s27
  s_waitcnt vmcnt(0)
  v_xor_b32 v39, v39, v59
  v_xor_b32 v43, v43, v59
  v_xor_b32 v47, v47, v59
  v_xor_b32 v51, v51, v59
  v_xor_b32 v55, v55, v59
  v_mov_b32 v184, v36
  v_mov_b32 v185, v37
  v_mov_b32 v186, v38
  v_mov_b32 v187, v40
  v_mov_b32 v188, v41
  v_mov_b32 v189, v42
  v_mov_b32 v190, v44
  v_mov_b32 v191, v45
  v_mov_b32 v192, v46
  v_mov_b32 v193, v48
  v_mov_b32 v194, v49
  v_mov_b32 v195, v50
  v_mov_b32 v196, v52
  v_mov_b32 v197, v53
  v_mov_b32 v198, v54
  v_mov_b32 v199, v56
  v_or3_b32 v39, v39, v43, v47
  v_or3_b32 v39, v39, v51, v55
  v_subrev_co_u32 v10, vcc, s26, v59
  v_subb_co_u32 v11, vcc, v57, v11, vcc
  v_or_b32 v11, v11, v39
  v_cmp_le_u64 vcc, s[24:25], v[10:11]
  s_add_u32 s46, s46, 1
  s_cbranch_vccz L_pollq_done
  s_cmp_lt_u32 s46, 1048576
  s_cbranch_scc1 L_pollq
L_pollq_done:
  v_readfirstlane_b32 s28, v59
  v_lshlrev_b32 v10, 4, v254
  v_lshl_add_u32 v10, v253, 11, v10
  s_lshr_b32 s45, s32, 1
  s_lshl_b32 s45, s45, 13
  s_add_u32 s45, s45, 98304
  s_lshl_b32 s46, s101, 8
  s_add_u32 s46, s46, s45
  v_add_u32 v10, s46, v10
  ds_write_b128 v10, v[184:187] offset:0
  ds_write_b128 v10, v[188:191] offset:512
  ds_write_b128 v10, v[192:195] offset:1024
  ds_write_b128 v10, v[196:199] offset:1536
  v_add_u32 v11, s45, v1
  s_waitcnt lgkmcnt(0)
  s_barrier
  ds_read_b128 v[36:39], v11 offset:0
  ds_read_b128 v[40:43], v11 offset:1024
  ds_read_b128 v[44:47], v11 offset:2048
  ds_read_b128 v[48:51], v11 offset:3072
  ds_read_b128 v[52:55], v11 offset:4096
  ds_read_b128 v[56:59], v11 offset:5120
  ds_read_b128 v[60:63], v11 offset:6144
  ds_read_b128 v[64:67], v11 offset:7168
  s_mov_b32 s52, 13
  s_waitcnt lgkmcnt(0)
L_nodma:
  ds_read_b128 v[184:187], v12
  ds_read_b128 v[188:191], v13
  ds_read_b128 v[192:195], v14
  ds_read_b128 v[196:199], v15
  ds_read_b128 v[200:203], v16
  ds_read_b128 v[204:207], v17
  ds_read_b128 v[208:211], v18
  ds_read_b128 v[212:215], v19
  v_fma_f32 v152, v168, s41, -v24
  v_fma_f32 v153, v169, s41, -v24
  v_fma_f32 v154, v170, s41, -v24
  v_fma_f32 v155, v171, s41, -v24
  v_fma_f32 v156, v172, s41, -v24
  v_fma_f32 v157, v173, s41, -v24
  v_fma_f32 v158, v174, s41, -v24
  v_fma_f32 v159, v175, s41, -v24
  v_fma_f32 v160, v176, s41, -v24
  v_fma_f32 v161, v177, s41, -v24
  v_fma_f32 v162, v178, s41, -v24
  v_fma_f32 v163, v179, s41, -v24
  v_fma_f32 v164, v180, s41, -v24
  v_fma_f32 v165, v181, s41, -v24
  v_fma_f32 v166, v182, s41, -v24
  v_fma_f32 v167, v183, s41, -v24
  s_add_u32 s55, s55, 1
  s_cmp_ge_u32 s55, 5
  s_cselect_b32 s100, 0xffff0000, s99
  s_cselect_b32 s55, 0, s55
  s_waitcnt lgkmcnt(7)
  v_mfma_f32_32x32x16_bf16 v[168:183], v[184:187], v[36:39], 0
  ds_read_b64_tr_b16 v[184:185], v22 offset:0
  ds_read_b64_tr_b16 v[186:187], v22 offset:2048
  v_exp_f32 v152, v152
  v_exp_f32 v153, v153
  v_exp_f32 v154, v154
  s_waitcnt lgkmcnt(8)
  v_mfma_f32_32x32x16_bf16 v[168:183], v[188:191], v[40:43], v[168:183]
  ds_read_b64_tr_b16 v[188:189], v23 offset:0
  ds_read_b64_tr_b16 v[190:191], v23 offset:2048
  v_exp_f32 v155, v155
  v_cvt_pk_bf16_f32 v152, v152, v153
  v_exp_f32 v156, v156
  s_waitcnt lgkmcnt(9)
  v_mfma_f32_32x32x16_bf16 v[168:183], v[192:195], v[44:47], v[168:183]
  ds_read_b64_tr_b16 v[192:193], v22 offset:4096
  ds_read_b64_tr_b16 v[194:195], v22 offset:6144
  v_exp_f32 v157, v157
  v_cvt_pk_bf16_f32 v153, v154, v155
  v_exp_f32 v158, v158
  s_waitcnt lgkmcnt(10)
  v_mfma_f32_32x32x16_bf16 v[168:183], v[196:199], v[48:51], v[168:183]
  ds_read_b64_tr_b16 v[196:197], v23 offset:4096
  ds_read_b64_tr_b16 v[198:199], v23 offset:6144
  v_exp_f32 v159, v159
  v_cvt_pk_bf16_f32 v154, v156, v157
  v_exp_f32 v160, v160
  s_waitcnt lgkmcnt(11)
  v_mfma_f32_32x32x16_bf16 v[168:183], v[200:203], v[52:55], v[168:183]
  ds_read_b64_tr_b16 v[200:201], v20 offset:0
  ds_read_b64_tr_b16 v[202:203], v20 offset:2048
  v_exp_f32 v161, v161
  v_cvt_pk_bf16_f32 v155, v158, v159
  v_exp_f32 v162, v162
  s_waitcnt lgkmcnt(12)
  v_mfma_f32_32x32x16_bf16 v[168:183], v[204:207], v[56:59], v[168:183]
  ds_read_b64_tr_b16 v[204:205], v21 offset:0
  ds_read_b64_tr_b16 v[206:207], v21 offset:2048
  v_exp_f32 v163, v163
  v_cvt_pk_bf16_f32 v156, v160, v161
  v_exp_f32 v164, v164
  s_waitcnt lgkmcnt(13)
  v_mfma_f32_32x32x16_bf16 v[168:183], v[208:211], v[60:63], v[168:183]
  ds_read_b64_tr_b16 v[208:209], v20 offset:4096
  ds_read_b64_tr_b16 v[210:211], v20 offset:6144
  v_exp_f32 v165, v165
  v_cvt_pk_bf16_f32 v157, v162, v163
  v_exp_f32 v166, v166
  v_exp_f32 v167, v167
  s_waitcnt lgkmcnt(14)
  v_mfma_f32_32x32x16_bf16 v[168:183], v[212:215], v[64:67], v[168:183]
  v_cvt_pk_bf16_f32 v158, v164, v165
  s_nop 0
  v_cvt_pk_bf16_f32 v159, v166, v167
  s_waitcnt lgkmcnt(12)
  ds_read_b64_tr_b16 v[212:213], v21 offset:4096
  ds_read_b64_tr_b16 v[214:215], v21 offset:6144
  v_mfma_f32_32x32x16_bf16 v[120:135], v[184:187], v[152:155], v[120:135]
  v_add_u32 v12, s48, v12
  v_add_u32 v13, s48, v13
  v_add_u32 v14, s48, v14
  s_waitcnt lgkmcnt(10)
  v_mfma_f32_32x32x16_bf16 v[136:151], v[188:191], v[152:155], v[136:151]
  v_add_u32 v15, s48, v15
  v_add_u32 v16, s48, v16
  v_add_u32 v17, s48, v17
  v_add_u32 v18, s48, v18
  v_add_u32 v19, s48, v19
  v_mfma_f32_32x32x16_bf16 v[120:135], v[192:195], v[156:159], v[120:135]
  v_add_u32 v20, s100, v20
  v_add_u32 v21, s100, v21
  s_waitcnt lgkmcnt(6)
  v_mfma_f32_32x32x16_bf16 v[136:151], v[196:199], v[156:159], v[136:151]
  v_add_u32 v22, s100, v22
  v_add_u32 v23, s100, v23
  v_max3_f32 v25, v168, v169, v170
  v_max3_f32 v8, v171, v172, v173
  v_max3_f32 v25, v25, v174, v175
  v_mfma_f32_32x32x16_bf16 v[88:103], v[200:203], v[152:155], v[88:103]
  v_max3_f32 v8, v8, v176, v177
  v_max3_f32 v25, v25, v178, v179
  v_max3_f32 v8, v8, v180, v181
  s_waitcnt lgkmcnt(2)
  v_mfma_f32_32x32x16_bf16 v[104:119], v[204:207], v[152:155], v[104:119]
  v_max3_f32 v25, v25, v182, v183
  v_max_f32 v25, v25, v8
  v_mov_b32 v8, v25
  s_mov_b32 s48, s100
  v_mfma_f32_32x32x16_bf16 v[88:103], v[208:211], v[156:159], v[88:103]
  v_permlane32_swap_b32 v25, v8
  s_nop 0
  v_max_f32 v25, v25, v8
  v_sub_f32 v8, v25, v3
  s_waitcnt lgkmcnt(0)
  v_mfma_f32_32x32x16_bf16 v[104:119], v[212:215], v[156:159], v[104:119]
  v_cmp_lt_f32 vcc, s98, v8
  v_mfma_f32_16x16x32_bf16 v[32:35], v[28:31], v[152:155], v[32:35]
  v_mfma_f32_16x16x32_bf16 v[32:35], v[28:31], v[156:159], v[32:35]
  s_cbranch_vccz L_norsf
  s_call_b64 s[96:97], L_rescale
L_norsf:
  s_cmp_eq_u32 s54, 0
  s_cbranch_scc1 L_loop_end
  v_lshrrev_b32 v10, 2, v1
  v_add_u32 v10, s38, v10
  ds_write_b32 v10, v3
  v_xor_b32 v9, 4096, v10
  s_waitcnt lgkmcnt(0)
  s_barrier
  ds_read_b32 v25, v9
  s_waitcnt lgkmcnt(0)
  s_call_b64 s[96:97], L_rescale
  s_branch L_loop_end
L_g2:
  v_lshlrev_b32 v8, 16, v253
  v_lshl_add_u32 v8, v254, 4, v8
  v_add_u32 v68, 0, v8
  v_add_u32 v69, 8192, v8
  v_add_u32 v70, 16384, v8
  v_add_u32 v71, 24576, v8
  v_add_u32 v72, 32768, v8
  v_add_u32 v73, 40960, v8
  v_add_u32 v74, 49152, v8
  v_add_u32 v75, 57344, v8
  s_mov_b32 s52, s34
  s_mul_i32 s49, s101, 2359296
  s_lshl_b32 s45, s33, 9
  s_add_u32 s49, s49, s45
  s_lshr_b32 s45, s32, 1
  s_lshl_b32 s45, s45, 8
  s_add_u32 s49, s49, s45
  s_mul_i32 s50, s34, 36864
  s_mul_i32 s45, s32, 9216
  s_add_u32 s50, s50, s45
  s_add_u32 s45, s45, 65536
  s_lshl_b32 s44, s101, 6
  v_xor_b32 v9, s44, v1
  v_add_u32 v8, 0, v253
  v_mul_u32_u24 v8, 57, v8
  v_lshrrev_b32 v8, 9, v8
  v_lshlrev_b32 v8, 4, v8
  v_xor_b32 v78, v8, v9
  v_add_u32 v8, 4, v253
  v_mul_u32_u24 v8, 57, v8
  v_lshrrev_b32 v8, 9, v8
  v_lshlrev_b32 v8, 4, v8
  v_xor_b32 v79, v8, v9
  v_add_u32 v8, 8, v253
  v_mul_u32_u24 v8, 57, v8
  v_lshrrev_b32 v8, 9, v8
  v_lshlrev_b32 v8, 4, v8
  v_xor_b32 v80, v8, v9
  v_add_u32 v8, 12, v253
  v_mul_u32_u24 v8, 57, v8
  v_lshrrev_b32 v8, 9, v8
  v_lshlrev_b32 v8, 4, v8
  v_xor_b32 v81, v8, v9
  v_add_u32 v8, 16, v253
  v_mul_u32_u24 v8, 57, v8
  v_lshrrev_b32 v8, 9, v8
  v_lshlrev_b32 v8, 4, v8
  v_xor_b32 v82, v8, v9
  v_add_u32 v8, 20, v253
  v_mul_u32_u24 v8, 57, v8
  v_lshrrev_b32 v8, 9, v8
  v_lshlrev_b32 v8, 4, v8
  v_xor_b32 v83, v8, v9
  v_add_u32 v8, 24, v253
  v_mul_u32_u24 v8, 57, v8
  v_lshrrev_b32 v8, 9, v8
  v_lshlrev_b32 v8, 4, v8
  v_xor_b32 v84, v8, v9
  v_add_u32 v8, 28, v253
  v_mul_u32_u24 v8, 57, v8
  v_lshrrev_b32 v8, 9, v8
  v_lshlrev_b32 v8, 4, v8
  v_xor_b32 v85, v8, v9
  v_add_u32 v8, 32, v253
  v_mul_u32_u24 v8, 57, v8
  v_lshrrev_b32 v8, 9, v8
  v_lshlrev_b32 v8, 4, v8
  v_xor_b32 v86, v8, v9
  s_waitcnt lgkmcnt(0)
  s_mov_b32 s12, s80
  s_and_b32 s13, s81, 0xffff
  s_mov_b32 s14, 0x48000
  s_mov_b32 s15, 0x20000
  s_mov_b32 m0, s45
  s_add_u32 s45, s45, 4096
  buffer_load_dwordx4 v78, s[12:15], s50 offen offset:0 lds
  buffer_load_dwordx4 v79, s[12:15], s50 offen offset:1024 lds
  buffer_load_dwordx4 v80, s[12:15], s50 offen offset:2048 lds
  buffer_load_dwordx4 v81, s[12:15], s50 offen offset:3072 lds
  s_add_u32 s50, s50, 4096
  s_mov_b32 m0, s45
  s_add_u32 s45, s45, 4096
  buffer_load_dwordx4 v82, s[12:15], s50 offen offset:0 lds
  buffer_load_dwordx4 v83, s[12:15], s50 offen offset:1024 lds
  buffer_load_dwordx4 v84, s[12:15], s50 offen offset:2048 lds
  buffer_load_dwordx4 v85, s[12:15], s50 offen offset:3072 lds
  s_add_u32 s50, s50, 4096
  s_mov_b32 m0, s45
  s_add_u32 s45, s45, 4096
  buffer_load_dwordx4 v86, s[12:15], s50 offen offset:0 lds
  s_mov_b32 s16, s86
  s_and_b32 s17, s87, 0xffff
  s_mov_b32 s18, 0x480000
  s_mov_b32 s19, 0x20000
  s_lshl_b32 s44, s52, 18
  s_add_u32 s44, s44, s49
  buffer_load_dwordx4 v[88:91], v68, s[16:19], s44 offen
  buffer_load_dwordx4 v[92:95], v69, s[16:19], s44 offen
  buffer_load_dwordx4 v[96:99], v70, s[16:19], s44 offen
  buffer_load_dwordx4 v[100:103], v71, s[16:19], s44 offen
  buffer_load_dwordx4 v[104:107], v72, s[16:19], s44 offen
  buffer_load_dwordx4 v[108:111], v73, s[16:19], s44 offen
  buffer_load_dwordx4 v[112:115], v74, s[16:19], s44 offen
  buffer_load_dwordx4 v[116:119], v75, s[16:19], s44 offen
  s_add_u32 s52, s52, 1
  s_cmp_eq_u32 s52, 9
  s_cselect_b32 s52, 0, s52
  s_add_u32 s4, s82, s46
  s_addc_u32 s5, s83, 0
  s_and_b32 s5, s5, 0xffff
  s_lshl_b32 s6, s53, 14
  s_mov_b32 s7, 0x20000
  s_sub_u32 s46, s46, 16384
  s_add_u32 s8, s84, s46
  s_addc_u32 s9, s85, 0
  s_and_b32 s9, s9, 0xffff
  s_add_u32 s10, s6, 16384
  s_mov_b32 s11, 0x20000
  s_mov_b32 s36, s51
  s_mov_b32 s38, s51
  s_mov_b32 s20, s94
  s_and_b32 s21, s95, 0xffff
  s_mov_b32 s22, 0x40000000
  s_mov_b32 s23, 0x20000
  v_or_b32 v8, 0, v253
  v_xor_b32 v8, v8, v254
  v_lshlrev_b32 v8, 4, v8
  v_lshl_add_u32 v4, v253, 8, v8
  s_lshl_b32 s44, s52, 18
  v_or_b32 v8, 4, v253
  v_xor_b32 v8, v8, v254
  v_lshlrev_b32 v8, 4, v8
  s_add_u32 s44, s44, s49
  v_lshl_add_u32 v5, v253, 8, v8
  v_or_b32 v8, 8, v253
  v_xor_b32 v8, v8, v254
  v_lshlrev_b32 v8, 4, v8
  buffer_load_dwordx4 v[120:123], v68, s[16:19], s44 offen
  v_lshl_add_u32 v6, v253, 8, v8
  v_or_b32 v8, 12, v253
  v_xor_b32 v8, v8, v254
  buffer_load_dwordx4 v[124:127], v69, s[16:19], s44 offen
  v_lshlrev_b32 v8, 4, v8
  v_lshl_add_u32 v7, v253, 8, v8
  v_lshlrev_b32 v8, 2, v253
  buffer_load_dwordx4 v[128:131], v70, s[16:19], s44 offen
  v_xor_b32 v8, v8, v254
  v_lshlrev_b32 v8, 4, v8
  v_lshl_add_u32 v2, v253, 8, v8
  s_mov_b32 s41, 0x3e0293ee
  buffer_load_dwordx4 v[132:135], v71, s[16:19], s44 offen
  s_mov_b32 s98, 0x427af233
  s_mov_b32 s42, 0x05040100
  s_mov_b32 s43, 0x07060302
  buffer_load_dwordx4 v[136:139], v72, s[16:19], s44 offen
  s_mov_b32 s99, 16384
  s_mov_b32 s24, 0x1000000
  s_mov_b32 s25, 0
  buffer_load_dwordx4 v[140:143], v73, s[16:19], s44 offen
  v_and_b32 v8, 31, v252
  v_lshlrev_b32 v8, 8, v8
  v_mov_b32 v9, s101
  v_lshl_add_u32 v8, v9, 13, v8
  buffer_load_dwordx4 v[144:147], v74, s[16:19], s44 offen
  v_lshrrev_b32 v10, 5, v252
  v_xor_b32 v10, v10, v254
  v_xor_b32 v11, 0, v10
  buffer_load_dwordx4 v[148:151], v75, s[16:19], s44 offen
  v_lshl_add_u32 v12, v11, 4, v8
  v_xor_b32 v11, 2, v10
  v_lshl_add_u32 v13, v11, 4, v8
  s_add_u32 s52, s52, 1
  v_xor_b32 v11, 4, v10
  v_lshl_add_u32 v14, v11, 4, v8
  v_xor_b32 v11, 6, v10
  v_lshl_add_u32 v15, v11, 4, v8
  s_cmp_eq_u32 s52, 9
  v_xor_b32 v11, 8, v10
  v_lshl_add_u32 v16, v11, 4, v8
  v_xor_b32 v11, 10, v10
  s_cselect_b32 s52, 0, s52
  v_lshl_add_u32 v17, v11, 4, v8
  v_xor_b32 v11, 12, v10
  v_lshl_add_u32 v18, v11, 4, v8
  s_lshl_b32 s44, s52, 18
  v_xor_b32 v11, 14, v10
  v_lshl_add_u32 v19, v11, 4, v8
  v_lshrrev_b32 v10, 2, v254
  v_lshrrev_b32 v8, 5, v252
  s_add_u32 s44, s44, s49
  v_lshl_add_u32 v8, v8, 2, v10
  v_lshlrev_b32 v8, 8, v8
  v_lshl_add_u32 v8, v9, 13, v8
  buffer_load_dwordx4 v[152:155], v68, s[16:19], s44 offen
  v_and_b32 v11, 3, v254
  v_lshl_add_u32 v8, v11, 3, v8
  v_and_b32 v11, 1, v253
  buffer_load_dwordx4 v[156:159], v69, s[16:19], s44 offen
  v_lshl_add_u32 v8, v11, 5, v8
  v_add_u32 v8, 98304, v8
  v_lshlrev_b32 v9, 1, v9
  v_xor_b32 v10, v10, v9
  buffer_load_dwordx4 v[160:163], v70, s[16:19], s44 offen
  v_xor_b32 v11, 0, v10
  v_lshl_add_u32 v20, v11, 6, v8
  v_xor_b32 v11, 1, v10
  buffer_load_dwordx4 v[164:167], v71, s[16:19], s44 offen
  v_lshl_add_u32 v21, v11, 6, v8
  v_xor_b32 v11, 2, v10
  v_lshl_add_u32 v22, v11, 6, v8
  buffer_load_dwordx4 v[168:171], v72, s[16:19], s44 offen
  v_xor_b32 v11, 3, v10
  v_lshl_add_u32 v23, v11, 6, v8
  v_lshrrev_b32 v8, 2, v254
  v_xor_b32 v8, v8, v253
  buffer_load_dwordx4 v[172:175], v73, s[16:19], s44 offen
  v_and_b32 v8, 1, v8
  v_add_u32 v8, -1, v8
  v_and_b32 v28, 0x3f803f80, v8
  buffer_load_dwordx4 v[176:179], v74, s[16:19], s44 offen
  v_mov_b32 v29, v28
  v_mov_b32 v30, v28
  v_mov_b32 v31, v28
  buffer_load_dwordx4 v[180:183], v75, s[16:19], s44 offen
  v_mul_u32_u24 v8, 1152, v254
  v_mov_b32 v9, s101
  v_mul_u32_u24 v10, 18432, v9
  v_add3_u32 v76, v8, v10, s99
  s_add_u32 s52, s52, 1
  v_sub_u32 v77, v8, v10
  v_add_u32 v77, 34816, v77
  v_mul_u32_u24 v32, 576, v9
  s_cmp_eq_u32 s52, 9
  v_lshl_add_u32 v32, v253, 4, v32
  v_lshrrev_b32 v33, 1, v254
  v_lshlrev_b32 v33, 4, v33
  s_cselect_b32 s52, 0, s52
  s_waitcnt vmcnt(24)
  s_barrier
  s_mov_b32 s45, s34
  s_lshl_b32 s46, s45, 6
  v_add_u32 v10, s46, v32
  v_xor_b32 v10, v10, v33
  v_add_u32 v8, v10, v76
  ds_read_b128 a[64:67], v8 offset:49152
  v_add_u32 v9, v10, v77
  ds_read_b128 a[68:71], v9 offset:49152
  s_add_u32 s45, s45, 1
  s_cmp_eq_u32 s45, 9
  s_cselect_b32 s45, 0, s45
  s_lshl_b32 s46, s45, 6
  v_add_u32 v10, s46, v32
  v_xor_b32 v10, v10, v33
  v_add_u32 v8, v10, v76
  ds_read_b128 a[72:75], v8 offset:49152
  v_add_u32 v9, v10, v77
  ds_read_b128 a[76:79], v9 offset:49152
  s_add_u32 s45, s45, 1
  s_cmp_eq_u32 s45, 9
  s_cselect_b32 s45, 0, s45
  s_lshl_b32 s46, s45, 6
  v_add_u32 v10, s46, v32
  v_xor_b32 v10, v10, v33
  v_add_u32 v8, v10, v76
  ds_read_b128 a[80:83], v8 offset:49152
  v_add_u32 v9, v10, v77
  ds_read_b128 a[84:87], v9 offset:49152
  s_add_u32 s45, s45, 1
  s_cmp_eq_u32 s45, 9
  s_cselect_b32 s45, 0, s45
  s_lshl_b32 s46, s45, 6
  v_add_u32 v10, s46, v32
  v_xor_b32 v10, v10, v33
  v_add_u32 v8, v10, v76
  ds_read_b128 a[88:91], v8 offset:49152
  v_add_u32 v9, v10, v77
  ds_read_b128 a[92:95], v9 offset:49152
  s_add_u32 s45, s45, 1
  s_cmp_eq_u32 s45, 9
  s_cselect_b32 s45, 0, s45
  s_lshl_b32 s46, s45, 6
  v_add_u32 v10, s46, v32
  v_xor_b32 v10, v10, v33
  v_add_u32 v8, v10, v76
  ds_read_b128 a[96:99], v8 offset:49152
  v_add_u32 v9, v10, v77
  ds_read_b128 a[100:103], v9 offset:49152
  s_add_u32 s45, s45, 1
  s_cmp_eq_u32 s45, 9
  s_cselect_b32 s45, 0, s45
  s_lshl_b32 s46, s45, 6
  v_add_u32 v10, s46, v32
  v_xor_b32 v10, v10, v33
  v_add_u32 v8, v10, v76
  ds_read_b128 a[104:107], v8 offset:49152
  v_add_u32 v9, v10, v77
  ds_read_b128 a[108:111], v9 offset:49152
  s_add_u32 s45, s45, 1
  s_cmp_eq_u32 s45, 9
  s_cselect_b32 s45, 0, s45
  s_waitcnt lgkmcnt(4)
  s_lshl_b32 s46, s45, 6
  v_add_u32 v10, s46, v32
  v_xor_b32 v10, v10, v33
  v_add_u32 v8, v10, v76
  ds_read_b128 a[112:115], v8 offset:49152
  v_add_u32 v9, v10, v77
  ds_read_b128 a[116:119], v9 offset:49152
  s_add_u32 s45, s45, 1
  s_cmp_eq_u32 s45, 9
  s_cselect_b32 s45, 0, s45
  s_lshl_b32 s46, s45, 6
  v_add_u32 v10, s46, v32
  v_xor_b32 v10, v10, v33
  v_add_u32 v8, v10, v76
  ds_read_b128 a[120:123], v8 offset:49152
  v_add_u32 v9, v10, v77
  ds_read_b128 a[124:127], v9 offset:49152
  s_add_u32 s45, s45, 1
  s_cmp_eq_u32 s45, 9
  s_cselect_b32 s45, 0, s45
  s_lshl_b32 s46, s45, 6
  v_add_u32 v10, s46, v32
  v_xor_b32 v10, v10, v33
  v_add_u32 v8, v10, v76
  ds_read_b128 a[128:131], v8 offset:49152
  v_add_u32 v9, v10, v77
  ds_read_b128 a[132:135], v9 offset:49152
  s_add_u32 s45, s45, 1
  s_cmp_eq_u32 s45, 9
  s_cselect_b32 s45, 0, s45
  s_lshl_b32 s44, s52, 18
  s_add_u32 s44, s44, s49
  buffer_load_dwordx4 v[184:187], v68, s[16:19], s44 offen
  buffer_load_dwordx4 v[188:191], v69, s[16:19], s44 offen
  buffer_load_dwordx4 v[192:195], v70, s[16:19], s44 offen
  buffer_load_dwordx4 v[196:199], v71, s[16:19], s44 offen
  buffer_load_dwordx4 v[200:203], v72, s[16:19], s44 offen
  buffer_load_dwordx4 v[204:207], v73, s[16:19], s44 offen
  buffer_load_dwordx4 v[208:211], v74, s[16:19], s44 offen
  buffer_load_dwordx4 v[212:215], v75, s[16:19], s44 offen
  s_add_u32 s52, s52, 1
  s_cmp_eq_u32 s52, 9
  s_cselect_b32 s52, 0, s52
  s_waitcnt lgkmcnt(0)
  s_barrier
  s_waitcnt vmcnt(24)
  v_perm_b32 v36, v92, v88, s42
  v_perm_b32 v37, v100, v96, s42
  v_perm_b32 v38, v108, v104, s42
  v_perm_b32 v39, v116, v112, s42
  s_lshl_b32 s44, s52, 18
  v_perm_b32 v40, v92, v88, s43
  v_perm_b32 v41, v100, v96, s43
  v_perm_b32 v42, v108, v104, s43
  v_perm_b32 v43, v116, v112, s43
  s_add_u32 s44, s44, s49
  v_mfma_f32_16x16x32_bf16 a[0:3], v[36:39], a[64:67], 0
  v_perm_b32 v44, v93, v89, s42
  v_perm_b32 v45, v101, v97, s42
  v_mfma_f32_16x16x32_bf16 a[32:35], v[36:39], a[68:71], 0
  buffer_load_dwordx4 v[216:219], v68, s[16:19], s44 offen
  v_perm_b32 v46, v109, v105, s42
  v_perm_b32 v47, v117, v113, s42
  v_mfma_f32_16x16x32_bf16 a[4:7], v[40:43], a[64:67], 0
  buffer_load_dwordx4 v[220:223], v69, s[16:19], s44 offen
  v_perm_b32 v48, v93, v89, s43
  v_perm_b32 v49, v101, v97, s43
  v_mfma_f32_16x16x32_bf16 a[36:39], v[40:43], a[68:71], 0
  v_perm_b32 v50, v109, v105, s43
  buffer_load_dwordx4 v[224:227], v70, s[16:19], s44 offen
  v_perm_b32 v51, v117, v113, s43
  v_mfma_f32_16x16x32_bf16 a[8:11], v[44:47], a[64:67], 0
  v_perm_b32 v52, v94, v90, s42
  v_perm_b32 v53, v102, v98, s42
  buffer_load_dwordx4 v[228:231], v71, s[16:19], s44 offen
  v_mfma_f32_16x16x32_bf16 a[40:43], v[44:47], a[68:71], 0
  v_perm_b32 v54, v110, v106, s42
  v_perm_b32 v55, v118, v114, s42
  buffer_load_dwordx4 v[232:235], v72, s[16:19], s44 offen
  v_mfma_f32_16x16x32_bf16 a[12:15], v[48:51], a[64:67], 0
  v_perm_b32 v56, v94, v90, s43
  v_perm_b32 v57, v102, v98, s43
  v_mfma_f32_16x16x32_bf16 a[44:47], v[48:51], a[68:71], 0
  buffer_load_dwordx4 v[236:239], v73, s[16:19], s44 offen
  v_perm_b32 v58, v110, v106, s43
  v_perm_b32 v59, v118, v114, s43
  v_mfma_f32_16x16x32_bf16 a[16:19], v[52:55], a[64:67], 0
  v_perm_b32 v60, v95, v91, s42
  buffer_load_dwordx4 v[240:243], v74, s[16:19], s44 offen
  v_perm_b32 v61, v103, v99, s42
  v_mfma_f32_16x16x32_bf16 a[48:51], v[52:55], a[68:71], 0
  v_perm_b32 v62, v111, v107, s42
  buffer_load_dwordx4 v[244:247], v75, s[16:19], s44 offen
  v_perm_b32 v63, v119, v115, s42
  v_mfma_f32_16x16x32_bf16 a[20:23], v[56:59], a[64:67], 0
  v_perm_b32 v64, v95, v91, s43
  v_perm_b32 v65, v103, v99, s43
  s_add_u32 s52, s52, 1
  v_mfma_f32_16x16x32_bf16 a[52:55], v[56:59], a[68:71], 0
  v_perm_b32 v66, v111, v107, s43
  v_perm_b32 v67, v119, v115, s43
  v_mfma_f32_16x16x32_bf16 a[24:27], v[60:63], a[64:67], 0
  s_cmp_eq_u32 s52, 9
  v_mfma_f32_16x16x32_bf16 a[56:59], v[60:63], a[68:71], 0
  v_mfma_f32_16x16x32_bf16 a[28:31], v[64:67], a[64:67], 0
  v_mfma_f32_16x16x32_bf16 a[60:63], v[64:67], a[68:71], 0
  s_cselect_b32 s52, 0, s52
  s_waitcnt vmcnt(24)
  v_perm_b32 v36, v124, v120, s42
  v_perm_b32 v37, v132, v128, s42
  v_perm_b32 v38, v140, v136, s42
  v_perm_b32 v39, v148, v144, s42
  s_lshl_b32 s44, s52, 18
  v_perm_b32 v40, v124, v120, s43
  v_perm_b32 v41, v132, v128, s43
  v_perm_b32 v42, v140, v136, s43
  v_perm_b32 v43, v148, v144, s43
  s_add_u32 s44, s44, s49
  v_mfma_f32_16x16x32_bf16 a[0:3], v[36:39], a[72:75], a[0:3]
  v_perm_b32 v44, v125, v121, s42
  v_perm_b32 v45, v133, v129, s42
  v_mfma_f32_16x16x32_bf16 a[32:35], v[36:39], a[76:79], a[32:35]
  buffer_load_dwordx4 v[88:91], v68, s[16:19], s44 offen
  v_perm_b32 v46, v141, v137, s42
  v_perm_b32 v47, v149, v145, s42
  v_mfma_f32_16x16x32_bf16 a[4:7], v[40:43], a[72:75], a[4:7]
  buffer_load_dwordx4 v[92:95], v69, s[16:19], s44 offen
  v_perm_b32 v48, v125, v121, s43
  v_perm_b32 v49, v133, v129, s43
  v_mfma_f32_16x16x32_bf16 a[36:39], v[40:43], a[76:79], a[36:39]
  v_perm_b32 v50, v141, v137, s43
  buffer_load_dwordx4 v[96:99], v70, s[16:19], s44 offen
  v_perm_b32 v51, v149, v145, s43
  v_mfma_f32_16x16x32_bf16 a[8:11], v[44:47], a[72:75], a[8:11]
  v_perm_b32 v52, v126, v122, s42
  v_perm_b32 v53, v134, v130, s42
  buffer_load_dwordx4 v[100:103], v71, s[16:19], s44 offen
  v_mfma_f32_16x16x32_bf16 a[40:43], v[44:47], a[76:79], a[40:43]
  v_perm_b32 v54, v142, v138, s42
  v_perm_b32 v55, v150, v146, s42
  buffer_load_dwordx4 v[104:107], v72, s[16:19], s44 offen
  v_mfma_f32_16x16x32_bf16 a[12:15], v[48:51], a[72:75], a[12:15]
  v_perm_b32 v56, v126, v122, s43
  v_perm_b32 v57, v134, v130, s43
  v_mfma_f32_16x16x32_bf16 a[44:47], v[48:51], a[76:79], a[44:47]
  buffer_load_dwordx4 v[108:111], v73, s[16:19], s44 offen
  v_perm_b32 v58, v142, v138, s43
  v_perm_b32 v59, v150, v146, s43
  v_mfma_f32_16x16x32_bf16 a[16:19], v[52:55], a[72:75], a[16:19]
  v_perm_b32 v60, v127, v123, s42
  buffer_load_dwordx4 v[112:115], v74, s[16:19], s44 offen
  v_perm_b32 v61, v135, v131, s42
  v_mfma_f32_16x16x32_bf16 a[48:51], v[52:55], a[76:79], a[48:51]
  v_perm_b32 v62, v143, v139, s42
  buffer_load_dwordx4 v[116:119], v75, s[16:19], s44 offen
  v_perm_b32 v63, v151, v147, s42
  v_mfma_f32_16x16x32_bf16 a[20:23], v[56:59], a[72:75], a[20:23]
  v_perm_b32 v64, v127, v123, s43
  v_perm_b32 v65, v135, v131, s43
  s_add_u32 s52, s52, 1
  v_mfma_f32_16x16x32_bf16 a[52:55], v[56:59], a[76:79], a[52:55]
  v_perm_b32 v66, v143, v139, s43
  v_perm_b32 v67, v151, v147, s43
  v_mfma_f32_16x16x32_bf16 a[24:27], v[60:63], a[72:75], a[24:27]
  s_cmp_eq_u32 s52, 9
  v_mfma_f32_16x16x32_bf16 a[56:59], v[60:63], a[76:79], a[56:59]
  v_mfma_f32_16x16x32_bf16 a[28:31], v[64:67], a[72:75], a[28:31]
  v_mfma_f32_16x16x32_bf16 a[60:63], v[64:67], a[76:79], a[60:63]
  s_cselect_b32 s52, 0, s52
  s_waitcnt vmcnt(24)
  v_perm_b32 v36, v156, v152, s42
  v_perm_b32 v37, v164, v160, s42
  v_perm_b32 v38, v172, v168, s42
  v_perm_b32 v39, v180, v176, s42
  s_lshl_b32 s44, s52, 18
  v_perm_b32 v40, v156, v152, s43
  v_perm_b32 v41, v164, v160, s43
  v_perm_b32 v42, v172, v168, s43
  v_perm_b32 v43, v180, v176, s43
  s_add_u32 s44, s44, s49
  v_mfma_f32_16x16x32_bf16 a[0:3], v[36:39], a[80:83], a[0:3]
  v_perm_b32 v44, v157, v153, s42
  v_perm_b32 v45, v165, v161, s42
  v_mfma_f32_16x16x32_bf16 a[32:35], v[36:39], a[84:87], a[32:35]
  buffer_load_dwordx4 v[120:123], v68, s[16:19], s44 offen
  v_perm_b32 v46, v173, v169, s42
  v_perm_b32 v47, v181, v177, s42
  v_mfma_f32_16x16x32_bf16 a[4:7], v[40:43], a[80:83], a[4:7]
  buffer_load_dwordx4 v[124:127], v69, s[16:19], s44 offen
  v_perm_b32 v48, v157, v153, s43
  v_perm_b32 v49, v165, v161, s43
  v_mfma_f32_16x16x32_bf16 a[36:39], v[40:43], a[84:87], a[36:39]
  v_perm_b32 v50, v173, v169, s43
  buffer_load_dwordx4 v[128:131], v70, s[16:19], s44 offen
  v_perm_b32 v51, v181, v177, s43
  v_mfma_f32_16x16x32_bf16 a[8:11], v[44:47], a[80:83], a[8:11]
  v_perm_b32 v52, v158, v154, s42
  v_perm_b32 v53, v166, v162, s42
  buffer_load_dwordx4 v[132:135], v71, s[16:19], s44 offen
  v_mfma_f32_16x16x32_bf16 a[40:43], v[44:47], a[84:87], a[40:43]
  v_perm_b32 v54, v174, v170, s42
  v_perm_b32 v55, v182, v178, s42
  buffer_load_dwordx4 v[136:139], v72, s[16:19], s44 offen
  v_mfma_f32_16x16x32_bf16 a[12:15], v[48:51], a[80:83], a[12:15]
  v_perm_b32 v56, v158, v154, s43
  v_perm_b32 v57, v166, v162, s43
  v_mfma_f32_16x16x32_bf16 a[44:47], v[48:51], a[84:87], a[44:47]
  buffer_load_dwordx4 v[140:143], v73, s[16:19], s44 offen
  v_perm_b32 v58, v174, v170, s43
  v_perm_b32 v59, v182, v178, s43
  v_mfma_f32_16x16x32_bf16 a[16:19], v[52:55], a[80:83], a[16:19]
  v_perm_b32 v60, v159, v155, s42
  buffer_load_dwordx4 v[144:147], v74, s[16:19], s44 offen
  v_perm_b32 v61, v167, v163, s42
  v_mfma_f32_16x16x32_bf16 a[48:51], v[52:55], a[84:87], a[48:51]
  v_perm_b32 v62, v175, v171, s42
  buffer_load_dwordx4 v[148:151], v75, s[16:19], s44 offen
  v_perm_b32 v63, v183, v179, s42
  v_mfma_f32_16x16x32_bf16 a[20:23], v[56:59], a[80:83], a[20:23]
  v_perm_b32 v64, v159, v155, s43
  v_perm_b32 v65, v167, v163, s43
  s_add_u32 s52, s52, 1
  v_mfma_f32_16x16x32_bf16 a[52:55], v[56:59], a[84:87], a[52:55]
  v_perm_b32 v66, v175, v171, s43
  v_perm_b32 v67, v183, v179, s43
  v_mfma_f32_16x16x32_bf16 a[24:27], v[60:63], a[80:83], a[24:27]
  s_cmp_eq_u32 s52, 9
  v_mfma_f32_16x16x32_bf16 a[56:59], v[60:63], a[84:87], a[56:59]
  v_mfma_f32_16x16x32_bf16 a[28:31], v[64:67], a[80:83], a[28:31]
  v_mfma_f32_16x16x32_bf16 a[60:63], v[64:67], a[84:87], a[60:63]
  s_cselect_b32 s52, 0, s52
  s_waitcnt vmcnt(24)
  v_perm_b32 v36, v188, v184, s42
  v_perm_b32 v37, v196, v192, s42
  v_perm_b32 v38, v204, v200, s42
  v_perm_b32 v39, v212, v208, s42
  s_lshl_b32 s44, s52, 18
  v_perm_b32 v40, v188, v184, s43
  v_perm_b32 v41, v196, v192, s43
  v_perm_b32 v42, v204, v200, s43
  v_perm_b32 v43, v212, v208, s43
  s_add_u32 s44, s44, s49
  v_mfma_f32_16x16x32_bf16 a[0:3], v[36:39], a[88:91], a[0:3]
  v_perm_b32 v44, v189, v185, s42
  v_perm_b32 v45, v197, v193, s42
  v_mfma_f32_16x16x32_bf16 a[32:35], v[36:39], a[92:95], a[32:35]
  buffer_load_dwordx4 v[152:155], v68, s[16:19], s44 offen
  v_perm_b32 v46, v205, v201, s42
  v_perm_b32 v47, v213, v209, s42
  v_mfma_f32_16x16x32_bf16 a[4:7], v[40:43], a[88:91], a[4:7]
  buffer_load_dwordx4 v[156:159], v69, s[16:19], s44 offen
  v_perm_b32 v48, v189, v185, s43
  v_perm_b32 v49, v197, v193, s43
  v_mfma_f32_16x16x32_bf16 a[36:39], v[40:43], a[92:95], a[36:39]
  v_perm_b32 v50, v205, v201, s43
  buffer_load_dwordx4 v[160:163], v70, s[16:19], s44 offen
  v_perm_b32 v51, v213, v209, s43
  v_mfma_f32_16x16x32_bf16 a[8:11], v[44:47], a[88:91], a[8:11]
  v_perm_b32 v52, v190, v186, s42
  v_perm_b32 v53, v198, v194, s42
  buffer_load_dwordx4 v[164:167], v71, s[16:19], s44 offen
  v_mfma_f32_16x16x32_bf16 a[40:43], v[44:47], a[92:95], a[40:43]
  v_perm_b32 v54, v206, v202, s42
  v_perm_b32 v55, v214, v210, s42
  buffer_load_dwordx4 v[168:171], v72, s[16:19], s44 offen
  v_mfma_f32_16x16x32_bf16 a[12:15], v[48:51], a[88:91], a[12:15]
  v_perm_b32 v56, v190, v186, s43
  v_perm_b32 v57, v198, v194, s43
  v_mfma_f32_16x16x32_bf16 a[44:47], v[48:51], a[92:95], a[44:47]
  buffer_load_dwordx4 v[172:175], v73, s[16:19], s44 offen
  v_perm_b32 v58, v206, v202, s43
  v_perm_b32 v59, v214, v210, s43
  v_mfma_f32_16x16x32_bf16 a[16:19], v[52:55], a[88:91], a[16:19]
  v_perm_b32 v60, v191, v187, s42
  buffer_load_dwordx4 v[176:179], v74, s[16:19], s44 offen
  v_perm_b32 v61, v199, v195, s42
  v_mfma_f32_16x16x32_bf16 a[48:51], v[52:55], a[92:95], a[48:51]
  v_perm_b32 v62, v207, v203, s42
  buffer_load_dwordx4 v[180:183], v75, s[16:19], s44 offen
  v_perm_b32 v63, v215, v211, s42
  v_mfma_f32_16x16x32_bf16 a[20:23], v[56:59], a[88:91], a[20:23]
  v_perm_b32 v64, v191, v187, s43
  v_perm_b32 v65, v199, v195, s43
  s_add_u32 s52, s52, 1
  v_mfma_f32_16x16x32_bf16 a[52:55], v[56:59], a[92:95], a[52:55]
  v_perm_b32 v66, v207, v203, s43
  v_perm_b32 v67, v215, v211, s43
  v_mfma_f32_16x16x32_bf16 a[24:27], v[60:63], a[88:91], a[24:27]
  s_cmp_eq_u32 s52, 9
  v_mfma_f32_16x16x32_bf16 a[56:59], v[60:63], a[92:95], a[56:59]
  v_mfma_f32_16x16x32_bf16 a[28:31], v[64:67], a[88:91], a[28:31]
  v_mfma_f32_16x16x32_bf16 a[60:63], v[64:67], a[92:95], a[60:63]
  s_cselect_b32 s52, 0, s52
  s_waitcnt vmcnt(24)
  v_perm_b32 v36, v220, v216, s42
  v_perm_b32 v37, v228, v224, s42
  v_perm_b32 v38, v236, v232, s42
  v_perm_b32 v39, v244, v240, s42
  s_lshl_b32 s44, s52, 18
  v_perm_b32 v40, v220, v216, s43
  v_perm_b32 v41, v228, v224, s43
  v_perm_b32 v42, v236, v232, s43
  v_perm_b32 v43, v244, v240, s43
  s_add_u32 s44, s44, s49
  v_mfma_f32_16x16x32_bf16 a[0:3], v[36:39], a[96:99], a[0:3]
  v_perm_b32 v44, v221, v217, s42
  v_perm_b32 v45, v229, v225, s42
  v_mfma_f32_16x16x32_bf16 a[32:35], v[36:39], a[100:103], a[32:35]
  buffer_load_dwordx4 v[184:187], v68, s[16:19], s44 offen
  v_perm_b32 v46, v237, v233, s42
  v_perm_b32 v47, v245, v241, s42
  v_mfma_f32_16x16x32_bf16 a[4:7], v[40:43], a[96:99], a[4:7]
  buffer_load_dwordx4 v[188:191], v69, s[16:19], s44 offen
  v_perm_b32 v48, v221, v217, s43
  v_perm_b32 v49, v229, v225, s43
  v_mfma_f32_16x16x32_bf16 a[36:39], v[40:43], a[100:103], a[36:39]
  v_perm_b32 v50, v237, v233, s43
  buffer_load_dwordx4 v[192:195], v70, s[16:19], s44 offen
  v_perm_b32 v51, v245, v241, s43
  v_mfma_f32_16x16x32_bf16 a[8:11], v[44:47], a[96:99], a[8:11]
  v_perm_b32 v52, v222, v218, s42
  v_perm_b32 v53, v230, v226, s42
  buffer_load_dwordx4 v[196:199], v71, s[16:19], s44 offen
  v_mfma_f32_16x16x32_bf16 a[40:43], v[44:47], a[100:103], a[40:43]
  v_perm_b32 v54, v238, v234, s42
  v_perm_b32 v55, v246, v242, s42
  buffer_load_dwordx4 v[200:203], v72, s[16:19], s44 offen
  v_mfma_f32_16x16x32_bf16 a[12:15], v[48:51], a[96:99], a[12:15]
  v_perm_b32 v56, v222, v218, s43
  v_perm_b32 v57, v230, v226, s43
  v_mfma_f32_16x16x32_bf16 a[44:47], v[48:51], a[100:103], a[44:47]
  buffer_load_dwordx4 v[204:207], v73, s[16:19], s44 offen
  v_perm_b32 v58, v238, v234, s43
  v_perm_b32 v59, v246, v242, s43
  v_mfma_f32_16x16x32_bf16 a[16:19], v[52:55], a[96:99], a[16:19]
  v_perm_b32 v60, v223, v219, s42
  buffer_load_dwordx4 v[208:211], v74, s[16:19], s44 offen
  v_perm_b32 v61, v231, v227, s42
  v_mfma_f32_16x16x32_bf16 a[48:51], v[52:55], a[100:103], a[48:51]
  v_perm_b32 v62, v239, v235, s42
  buffer_load_dwordx4 v[212:215], v75, s[16:19], s44 offen
  v_perm_b32 v63, v247, v243, s42
  v_mfma_f32_16x16x32_bf16 a[20:23], v[56:59], a[96:99], a[20:23]
  v_perm_b32 v64, v223, v219, s43
  v_perm_b32 v65, v231, v227, s43
  s_add_u32 s52, s52, 1
  v_mfma_f32_16x16x32_bf16 a[52:55], v[56:59], a[100:103], a[52:55]
  v_perm_b32 v66, v239, v235, s43
  v_perm_b32 v67, v247, v243, s43
  v_mfma_f32_16x16x32_bf16 a[24:27], v[60:63], a[96:99], a[24:27]
  s_cmp_eq_u32 s52, 9
  v_mfma_f32_16x16x32_bf16 a[56:59], v[60:63], a[100:103], a[56:59]
  v_mfma_f32_16x16x32_bf16 a[28:31], v[64:67], a[96:99], a[28:31]
  v_mfma_f32_16x16x32_bf16 a[60:63], v[64:67], a[100:103], a[60:63]
  s_cselect_b32 s52, 0, s52
  s_waitcnt vmcnt(24)
  v_perm_b32 v36, v92, v88, s42
  v_perm_b32 v37, v100, v96, s42
  v_perm_b32 v38, v108, v104, s42
  v_perm_b32 v39, v116, v112, s42
  v_perm_b32 v40, v92, v88, s43
  s_mov_b32 m0, s38
  v_perm_b32 v41, v100, v96, s43
  v_perm_b32 v42, v108, v104, s43
  v_perm_b32 v43, v116, v112, s43
  v_mfma_f32_16x16x32_bf16 a[0:3], v[36:39], a[104:107], a[0:3]
  s_add_u32 s39, s38, 16384
  v_perm_b32 v44, v93, v89, s42
  v_perm_b32 v45, v101, v97, s42
  v_mfma_f32_16x16x32_bf16 a[32:35], v[36:39], a[108:111], a[32:35]
  v_perm_b32 v46, v109, v105, s42
  v_perm_b32 v47, v117, v113, s42
  buffer_load_dwordx4 v4, s[4:7], s36 offen offset:0 nt lds
  v_mfma_f32_16x16x32_bf16 a[4:7], v[40:43], a[104:107], a[4:7]
  v_perm_b32 v48, v93, v89, s43
  v_perm_b32 v49, v101, v97, s43
  v_mfma_f32_16x16x32_bf16 a[36:39], v[40:43], a[108:111], a[36:39]
  buffer_load_dwordx4 v5, s[4:7], s36 offen offset:1024 nt lds
  v_perm_b32 v50, v109, v105, s43
  v_perm_b32 v51, v117, v113, s43
  v_mfma_f32_16x16x32_bf16 a[8:11], v[44:47], a[104:107], a[8:11]
  v_perm_b32 v52, v94, v90, s42
  buffer_load_dwordx4 v6, s[4:7], s36 offen offset:2048 nt lds
  v_perm_b32 v53, v102, v98, s42
  v_mfma_f32_16x16x32_bf16 a[40:43], v[44:47], a[108:111], a[40:43]
  v_perm_b32 v54, v110, v106, s42
  v_perm_b32 v55, v118, v114, s42
  v_mfma_f32_16x16x32_bf16 a[12:15], v[48:51], a[104:107], a[12:15]
  buffer_load_dwordx4 v7, s[4:7], s36 offen offset:3072 nt lds
  v_perm_b32 v56, v94, v90, s43
  v_perm_b32 v57, v102, v98, s43
  v_mfma_f32_16x16x32_bf16 a[44:47], v[48:51], a[108:111], a[44:47]
  v_perm_b32 v58, v110, v106, s43
  s_cmp_ge_u32 s39, s47
  v_perm_b32 v59, v118, v114, s43
  v_mfma_f32_16x16x32_bf16 a[16:19], v[52:55], a[104:107], a[16:19]
  v_perm_b32 v60, v95, v91, s42
  v_perm_b32 v61, v103, v99, s42
  s_cselect_b32 s38, s51, s39
  v_mfma_f32_16x16x32_bf16 a[48:51], v[52:55], a[108:111], a[48:51]
  v_perm_b32 v62, v111, v107, s42
  v_perm_b32 v63, v119, v115, s42
  v_mfma_f32_16x16x32_bf16 a[20:23], v[56:59], a[104:107], a[20:23]
  v_perm_b32 v64, v95, v91, s43
  s_add_u32 m0, s38, 81920
  v_perm_b32 v65, v103, v99, s43
  v_mfma_f32_16x16x32_bf16 a[52:55], v[56:59], a[108:111], a[52:55]
  v_perm_b32 v66, v111, v107, s43
  v_perm_b32 v67, v119, v115, s43
  s_nop 0
  v_mfma_f32_16x16x32_bf16 a[24:27], v[60:63], a[104:107], a[24:27]
  v_mfma_f32_16x16x32_bf16 a[56:59], v[60:63], a[108:111], a[56:59]
  v_mfma_f32_16x16x32_bf16 a[28:31], v[64:67], a[104:107], a[28:31]
  v_mfma_f32_16x16x32_bf16 a[60:63], v[64:67], a[108:111], a[60:63]
  s_add_u32 s36, s36, 16384
  s_waitcnt vmcnt(20)
  v_perm_b32 v36, v124, v120, s42
  v_perm_b32 v37, v132, v128, s42
  v_perm_b32 v38, v140, v136, s42
  v_perm_b32 v39, v148, v144, s42
  s_mov_b32 m0, s38
  v_perm_b32 v40, v124, v120, s43
  v_perm_b32 v41, v132, v128, s43
  v_perm_b32 v42, v140, v136, s43
  s_add_u32 s39, s38, 16384
  v_perm_b32 v43, v148, v144, s43
  v_mfma_f32_16x16x32_bf16 a[0:3], v[36:39], a[112:115], a[0:3]
  v_perm_b32 v44, v125, v121, s42
  buffer_load_dwordx4 v4, s[4:7], s36 offen offset:0 nt lds
  v_perm_b32 v45, v133, v129, s42
  v_mfma_f32_16x16x32_bf16 a[32:35], v[36:39], a[116:119], a[32:35]
  v_perm_b32 v46, v141, v137, s42
  buffer_load_dwordx4 v5, s[4:7], s36 offen offset:1024 nt lds
  v_perm_b32 v47, v149, v145, s42
  v_mfma_f32_16x16x32_bf16 a[4:7], v[40:43], a[112:115], a[4:7]
  v_perm_b32 v48, v125, v121, s43
  buffer_load_dwordx4 v6, s[4:7], s36 offen offset:2048 nt lds
  v_perm_b32 v49, v133, v129, s43
  v_mfma_f32_16x16x32_bf16 a[36:39], v[40:43], a[116:119], a[36:39]
  v_perm_b32 v50, v141, v137, s43
  v_perm_b32 v51, v149, v145, s43
  buffer_load_dwordx4 v7, s[4:7], s36 offen offset:3072 nt lds
  v_mfma_f32_16x16x32_bf16 a[8:11], v[44:47], a[112:115], a[8:11]
  v_perm_b32 v52, v126, v122, s42
  v_perm_b32 v53, v134, v130, s42
  s_cmp_ge_u32 s39, s47
  v_mfma_f32_16x16x32_bf16 a[40:43], v[44:47], a[116:119], a[40:43]
  v_perm_b32 v54, v142, v138, s42
  v_perm_b32 v55, v150, v146, s42
  s_cselect_b32 s38, s51, s39
  v_mfma_f32_16x16x32_bf16 a[12:15], v[48:51], a[112:115], a[12:15]
  v_perm_b32 v56, v126, v122, s43
  v_perm_b32 v57, v134, v130, s43
  s_add_u32 m0, s38, 81920
  v_mfma_f32_16x16x32_bf16 a[44:47], v[48:51], a[116:119], a[44:47]
  v_perm_b32 v58, v142, v138, s43
  v_perm_b32 v59, v150, v146, s43
  s_nop 0
  v_mfma_f32_16x16x32_bf16 a[16:19], v[52:55], a[112:115], a[16:19]
  v_perm_b32 v60, v127, v123, s42
  v_perm_b32 v61, v135, v131, s42
  v_mfma_f32_16x16x32_bf16 a[48:51], v[52:55], a[116:119], a[48:51]
  buffer_load_dwordx4 v2, s[8:11], s36 offen offset:0 nt lds
  v_perm_b32 v62, v143, v139, s42
  v_perm_b32 v63, v151, v147, s42
  v_mfma_f32_16x16x32_bf16 a[20:23], v[56:59], a[112:115], a[20:23]
  buffer_load_dwordx4 v2, s[8:11], s36 offen offset:1024 nt lds
  v_perm_b32 v64, v127, v123, s43
  v_perm_b32 v65, v135, v131, s43
  v_mfma_f32_16x16x32_bf16 a[52:55], v[56:59], a[116:119], a[52:55]
  buffer_load_dwordx4 v2, s[8:11], s36 offen offset:2048 nt lds
  v_perm_b32 v66, v143, v139, s43
  v_perm_b32 v67, v151, v147, s43
  v_mfma_f32_16x16x32_bf16 a[24:27], v[60:63], a[112:115], a[24:27]
  buffer_load_dwordx4 v2, s[8:11], s36 offen offset:3072 nt lds
  v_mfma_f32_16x16x32_bf16 a[56:59], v[60:63], a[116:119], a[56:59]
  v_mfma_f32_16x16x32_bf16 a[28:31], v[64:67], a[112:115], a[28:31]
  v_mfma_f32_16x16x32_bf16 a[60:63], v[64:67], a[116:119], a[60:63]
  s_add_u32 s36, s36, 16384
  s_waitcnt vmcnt(20)
  v_perm_b32 v36, v156, v152, s42
  v_perm_b32 v37, v164, v160, s42
  v_perm_b32 v38, v172, v168, s42
  v_perm_b32 v39, v180, v176, s42
  v_perm_b32 v40, v156, v152, s43
  v_perm_b32 v41, v164, v160, s43
  v_perm_b32 v42, v172, v168, s43
  v_perm_b32 v43, v180, v176, s43
  v_mfma_f32_16x16x32_bf16 a[0:3], v[36:39], a[120:123], a[0:3]
  v_perm_b32 v44, v157, v153, s42
  v_perm_b32 v45, v165, v161, s42
  v_mfma_f32_16x16x32_bf16 a[32:35], v[36:39], a[124:127], a[32:35]
  v_perm_b32 v46, v173, v169, s42
  v_perm_b32 v47, v181, v177, s42
  v_mfma_f32_16x16x32_bf16 a[4:7], v[40:43], a[120:123], a[4:7]
  v_perm_b32 v48, v157, v153, s43
  v_perm_b32 v49, v165, v161, s43
  v_mfma_f32_16x16x32_bf16 a[36:39], v[40:43], a[124:127], a[36:39]
  v_perm_b32 v50, v173, v169, s43
  v_perm_b32 v51, v181, v177, s43
  v_mfma_f32_16x16x32_bf16 a[8:11], v[44:47], a[120:123], a[8:11]
  v_perm_b32 v52, v158, v154, s42
  v_perm_b32 v53, v166, v162, s42
  v_mfma_f32_16x16x32_bf16 a[40:43], v[44:47], a[124:127], a[40:43]
  v_perm_b32 v54, v174, v170, s42
  v_perm_b32 v55, v182, v178, s42
  v_mfma_f32_16x16x32_bf16 a[12:15], v[48:51], a[120:123], a[12:15]
  v_perm_b32 v56, v158, v154, s43
  v_perm_b32 v57, v166, v162, s43
  v_mfma_f32_16x16x32_bf16 a[44:47], v[48:51], a[124:127], a[44:47]
  v_perm_b32 v58, v174, v170, s43
  v_perm_b32 v59, v182, v178, s43
  v_mfma_f32_16x16x32_bf16 a[16:19], v[52:55], a[120:123], a[16:19]
  v_perm_b32 v60, v159, v155, s42
  v_perm_b32 v61, v167, v163, s42
  v_mfma_f32_16x16x32_bf16 a[48:51], v[52:55], a[124:127], a[48:51]
  v_perm_b32 v62, v175, v171, s42
  v_perm_b32 v63, v183, v179, s42
  v_mfma_f32_16x16x32_bf16 a[20:23], v[56:59], a[120:123], a[20:23]
  v_perm_b32 v64, v159, v155, s43
  v_perm_b32 v65, v167, v163, s43
  v_mfma_f32_16x16x32_bf16 a[52:55], v[56:59], a[124:127], a[52:55]
  v_perm_b32 v66, v175, v171, s43
  v_perm_b32 v67, v183, v179, s43
  v_mfma_f32_16x16x32_bf16 a[24:27], v[60:63], a[120:123], a[24:27]
  v_mfma_f32_16x16x32_bf16 a[56:59], v[60:63], a[124:127], a[56:59]
  v_mfma_f32_16x16x32_bf16 a[28:31], v[64:67], a[120:123], a[28:31]
  v_mfma_f32_16x16x32_bf16 a[60:63], v[64:67], a[124:127], a[60:63]
  s_waitcnt vmcnt(12)
  v_perm_b32 v36, v188, v184, s42
  v_perm_b32 v37, v196, v192, s42
  v_perm_b32 v38, v204, v200, s42
  v_perm_b32 v39, v212, v208, s42
  v_perm_b32 v40, v188, v184, s43
  v_perm_b32 v41, v196, v192, s43
  v_perm_b32 v42, v204, v200, s43
  v_perm_b32 v43, v212, v208, s43
  v_mfma_f32_16x16x32_bf16 a[0:3], v[36:39], a[128:131], a[0:3]
  v_perm_b32 v44, v189, v185, s42
  v_perm_b32 v45, v197, v193, s42
  v_mfma_f32_16x16x32_bf16 a[32:35], v[36:39], a[132:135], a[32:35]
  v_perm_b32 v46, v205, v201, s42
  v_perm_b32 v47, v213, v209, s42
  v_mfma_f32_16x16x32_bf16 a[4:7], v[40:43], a[128:131], a[4:7]
  v_perm_b32 v48, v189, v185, s43
  v_perm_b32 v49, v197, v193, s43
  v_mfma_f32_16x16x32_bf16 a[36:39], v[40:43], a[132:135], a[36:39]
  v_perm_b32 v50, v205, v201, s43
  v_perm_b32 v51, v213, v209, s43
  v_mfma_f32_16x16x32_bf16 a[8:11], v[44:47], a[128:131], a[8:11]
  v_perm_b32 v52, v190, v186, s42
  v_perm_b32 v53, v198, v194, s42
  v_mfma_f32_16x16x32_bf16 a[40:43], v[44:47], a[132:135], a[40:43]
  v_perm_b32 v54, v206, v202, s42
  v_perm_b32 v55, v214, v210, s42
  v_mfma_f32_16x16x32_bf16 a[12:15], v[48:51], a[128:131], a[12:15]
  v_perm_b32 v56, v190, v186, s43
  v_perm_b32 v57, v198, v194, s43
  v_mfma_f32_16x16x32_bf16 a[44:47], v[48:51], a[132:135], a[44:47]
  v_perm_b32 v58, v206, v202, s43
  v_perm_b32 v59, v214, v210, s43
  v_mfma_f32_16x16x32_bf16 a[16:19], v[52:55], a[128:131], a[16:19]
  v_perm_b32 v60, v191, v187, s42
  v_perm_b32 v61, v199, v195, s42
  v_mfma_f32_16x16x32_bf16 a[48:51], v[52:55], a[132:135], a[48:51]
  v_perm_b32 v62, v207, v203, s42
  v_perm_b32 v63, v215, v211, s42
  v_mfma_f32_16x16x32_bf16 a[20:23], v[56:59], a[128:131], a[20:23]
  v_perm_b32 v64, v191, v187, s43
  v_perm_b32 v65, v199, v195, s43
  v_mfma_f32_16x16x32_bf16 a[52:55], v[56:59], a[132:135], a[52:55]
  v_perm_b32 v66, v207, v203, s43
  v_perm_b32 v67, v215, v211, s43
  v_mfma_f32_16x16x32_bf16 a[24:27], v[60:63], a[128:131], a[24:27]
  v_mfma_f32_16x16x32_bf16 a[56:59], v[60:63], a[132:135], a[56:59]
  v_mfma_f32_16x16x32_bf16 a[28:31], v[64:67], a[128:131], a[28:31]
  v_mfma_f32_16x16x32_bf16 a[60:63], v[64:67], a[132:135], a[60:63]
  s_memrealtime s[28:29]
  s_lshl_b32 s46, s32, 13
  s_add_u32 s46, s46, 65536
  s_xor_b32 s44, s46, 8192
  v_add_u32 v9, s44, v1
  v_add_u32 v10, s46, v1
  s_nop 1
  ds_write_b128 v9, a[32:35] offset:0
  ds_write_b128 v9, a[36:39] offset:1024
  ds_write_b128 v9, a[40:43] offset:2048
  ds_write_b128 v9, a[44:47] offset:3072
  ds_write_b128 v9, a[48:51] offset:4096
  ds_write_b128 v9, a[52:55] offset:5120
  ds_write_b128 v9, a[56:59] offset:6144
  ds_write_b128 v9, a[60:63] offset:7168
  v_accvgpr_read_b32 v184, a0
  v_accvgpr_read_b32 v185, a1
  v_accvgpr_read_b32 v186, a2
  v_accvgpr_read_b32 v187, a3
  v_accvgpr_read_b32 v188, a4
  v_accvgpr_read_b32 v189, a5
  v_accvgpr_read_b32 v190, a6
  v_accvgpr_read_b32 v191, a7
  v_accvgpr_read_b32 v192, a8
  v_accvgpr_read_b32 v193, a9
  v_accvgpr_read_b32 v194, a10
  v_accvgpr_read_b32 v195, a11
  v_accvgpr_read_b32 v196, a12
  v_accvgpr_read_b32 v197, a13
  v_accvgpr_read_b32 v198, a14
  v_accvgpr_read_b32 v199, a15
  v_accvgpr_read_b32 v200, a16
  v_accvgpr_read_b32 v201, a17
  v_accvgpr_read_b32 v202, a18
  v_accvgpr_read_b32 v203, a19
  v_accvgpr_read_b32 v204, a20
  v_accvgpr_read_b32 v205, a21
  v_accvgpr_read_b32 v206, a22
  v_accvgpr_read_b32 v207, a23
  v_accvgpr_read_b32 v208, a24
  v_accvgpr_read_b32 v209, a25
  v_accvgpr_read_b32 v210, a26
  v_accvgpr_read_b32 v211, a27
  v_accvgpr_read_b32 v212, a28
  v_accvgpr_read_b32 v213, a29
  v_accvgpr_read_b32 v214, a30
  v_accvgpr_read_b32 v215, a31
  s_waitcnt lgkmcnt(0)
  s_barrier
  ds_read_b128 v[36:39], v10 offset:0
  ds_read_b128 v[40:43], v10 offset:1024
  ds_read_b128 v[44:47], v10 offset:2048
  ds_read_b128 v[48:51], v10 offset:3072
  ds_read_b128 v[52:55], v10 offset:4096
  ds_read_b128 v[56:59], v10 offset:5120
  ds_read_b128 v[60:63], v10 offset:6144
  ds_read_b128 v[64:67], v10 offset:7168
  s_lshl_b32 s44, s35, 2
  s_add_u32 s44, s44, s32
  s_mul_i32 s44, s44, 6144
  s_add_u32 s45, s44, 4096
  v_mov_b32 v219, s28
  v_mov_b32 v223, s28
  v_mov_b32 v227, s28
  v_mov_b32 v231, s28
  v_mov_b32 v235, s28
  v_mov_b32 v239, s28
  v_mov_b32 v237, s29
  v_mov_b32 v238, 0
  s_waitcnt lgkmcnt(0)
  v_pk_add_f32 v[184:185], v[184:185], v[36:37]
  v_pk_add_f32 v[186:187], v[186:187], v[38:39]
  v_pk_add_f32 v[188:189], v[188:189], v[40:41]
  v_pk_add_f32 v[190:191], v[190:191], v[42:43]
  v_pk_add_f32 v[192:193], v[192:193], v[44:45]
  v_pk_add_f32 v[194:195], v[194:195], v[46:47]
  v_pk_add_f32 v[196:197], v[196:197], v[48:49]
  v_pk_add_f32 v[198:199], v[198:199], v[50:51]
  v_pk_add_f32 v[200:201], v[200:201], v[52:53]
  v_pk_add_f32 v[202:203], v[202:203], v[54:55]
  v_pk_add_f32 v[204:205], v[204:205], v[56:57]
  v_pk_add_f32 v[206:207], v[206:207], v[58:59]
  v_pk_add_f32 v[208:209], v[208:209], v[60:61]
  v_pk_add_f32 v[210:211], v[210:211], v[62:63]
  v_pk_add_f32 v[212:213], v[212:213], v[64:65]
  v_pk_add_f32 v[214:215], v[214:215], v[66:67]
  v_cvt_pk_bf16_f32 v216, v184, v188
  v_cvt_pk_bf16_f32 v217, v192, v196
  v_cvt_pk_bf16_f32 v218, v200, v204
  buffer_store_dwordx4 v[216:219], v1, s[20:23], s44 offen offset:0 sc1
  v_cvt_pk_bf16_f32 v220, v208, v212
  v_cvt_pk_bf16_f32 v221, v185, v189
  v_cvt_pk_bf16_f32 v222, v193, v197
  buffer_store_dwordx4 v[220:223], v1, s[20:23], s44 offen offset:1024 sc1
  v_cvt_pk_bf16_f32 v224, v201, v205
  v_cvt_pk_bf16_f32 v225, v209, v213
  v_cvt_pk_bf16_f32 v226, v186, v190
  buffer_store_dwordx4 v[224:227], v1, s[20:23], s44 offen offset:2048 sc1
  v_cvt_pk_bf16_f32 v228, v194, v198
  v_cvt_pk_bf16_f32 v229, v202, v206
  v_cvt_pk_bf16_f32 v230, v210, v214
  buffer_store_dwordx4 v[228:231], v1, s[20:23], s44 offen offset:3072 sc1
  v_cvt_pk_bf16_f32 v232, v187, v191
  v_cvt_pk_bf16_f32 v233, v195, v199
  v_cvt_pk_bf16_f32 v234, v203, v207
  buffer_store_dwordx4 v[232:235], v1, s[20:23], s45 offen offset:0 sc1
  v_cvt_pk_bf16_f32 v236, v211, v215
  buffer_store_dwordx4 v[236:239], v1, s[20:23], s45 offen offset:1024 sc1
  s_and_b32 s93, s93, 0xffff
  s_mov_b32 s94, 256
  s_mov_b32 s95, 0x20000
  s_cmp_eq_u32 s32, 3
  s_cbranch_scc0 L_noepb
  s_not_b64 s[44:45], s[30:31]
  v_mov_b32 v8, s44
  v_mov_b32 v9, s45
  s_lshl_b32 s44, s34, 5
  s_mov_b64 exec, 1
  buffer_atomic_umax_x2 v[8:9], off, s[92:95], s44 sc1
  s_mov_b64 exec, -1
L_noepb:
  v_mov_b32 v152, v216
  v_mov_b32 v153, v217
  v_mov_b32 v154, v218
  v_mov_b32 v155, v220
  v_mov_b32 v156, v221
  v_mov_b32 v157, v222
  v_mov_b32 v158, v224
  v_mov_b32 v159, v225
  v_mov_b32 v160, v226
  v_mov_b32 v161, v228
  v_mov_b32 v162, v229
  v_mov_b32 v163, v230
  v_mov_b32 v164, v232
  v_mov_b32 v165, v233
  v_mov_b32 v166, v234
  v_mov_b32 v167, v236
  v_lshlrev_b32 v10, 4, v254
  v_lshl_add_u32 v10, v253, 11, v10
  s_lshr_b32 s45, s32, 1
  s_lshl_b32 s45, s45, 13
  s_add_u32 s45, s45, 98304
  s_lshl_b32 s46, s101, 8
  s_add_u32 s46, s46, s45
  v_add_u32 v10, s46, v10
  ds_write_b128 v10, v[152:155] offset:0
  ds_write_b128 v10, v[156:159] offset:512
  ds_write_b128 v10, v[160:163] offset:1024
  ds_write_b128 v10, v[164:167] offset:1536
  v_add_u32 v11, s45, v1
  s_mov_b32 m0, s38
  s_add_u32 s39, s38, 16384
  buffer_load_dwordx4 v4, s[4:7], s36 offen offset:0 nt lds
  buffer_load_dwordx4 v5, s[4:7], s36 offen offset:1024 nt lds
  buffer_load_dwordx4 v6, s[4:7], s36 offen offset:2048 nt lds
  buffer_load_dwordx4 v7, s[4:7], s36 offen offset:3072 nt lds
  s_cmp_ge_u32 s39, s47
  s_cselect_b32 s38, s51, s39
  s_add_u32 m0, s38, 81920
  s_nop 0
  buffer_load_dwordx4 v2, s[8:11], s36 offen offset:0 nt lds
  buffer_load_dwordx4 v2, s[8:11], s36 offen offset:1024 nt lds
  buffer_load_dwordx4 v2, s[8:11], s36 offen offset:2048 nt lds
  buffer_load_dwordx4 v2, s[8:11], s36 offen offset:3072 nt lds
  s_add_u32 s36, s36, 16384
  s_waitcnt lgkmcnt(0)
  s_barrier
  ds_read_b128 v[36:39], v11 offset:0
  ds_read_b128 v[40:43], v11 offset:1024
  ds_read_b128 v[44:47], v11 offset:2048
  ds_read_b128 v[48:51], v11 offset:3072
  ds_read_b128 v[52:55], v11 offset:4096
  ds_read_b128 v[56:59], v11 offset:5120
  ds_read_b128 v[60:63], v11 offset:6144
  ds_read_b128 v[64:67], v11 offset:7168
  v_mov_b32 v88, 0
  v_mov_b32 v89, 0
  v_mov_b32 v90, 0
  v_mov_b32 v91, 0
  v_mov_b32 v92, 0
  v_mov_b32 v93, 0
  s_mov_b32 m0, s38
  v_mov_b32 v94, 0
  v_mov_b32 v95, 0
  v_mov_b32 v96, 0
  v_mov_b32 v97, 0
  v_mov_b32 v98, 0
  v_mov_b32 v99, 0
  s_add_u32 s39, s38, 16384
  v_mov_b32 v100, 0
  v_mov_b32 v101, 0
  v_mov_b32 v102, 0
  v_mov_b32 v103, 0
  v_mov_b32 v104, 0
  v_mov_b32 v105, 0
  buffer_load_dwordx4 v4, s[4:7], s36 offen offset:0 nt lds
  v_mov_b32 v106, 0
  v_mov_b32 v107, 0
  v_mov_b32 v108, 0
  v_mov_b32 v109, 0
  v_mov_b32 v110, 0
  v_mov_b32 v111, 0
  buffer_load_dwordx4 v5, s[4:7], s36 offen offset:1024 nt lds
  v_mov_b32 v112, 0
  v_mov_b32 v113, 0
  v_mov_b32 v114, 0
  v_mov_b32 v115, 0
  v_mov_b32 v116, 0
  v_mov_b32 v117, 0
  buffer_load_dwordx4 v6, s[4:7], s36 offen offset:2048 nt lds
  v_mov_b32 v118, 0
  v_mov_b32 v119, 0
  v_mov_b32 v120, 0
  v_mov_b32 v121, 0
  v_mov_b32 v122, 0
  v_mov_b32 v123, 0
  buffer_load_dwordx4 v7, s[4:7], s36 offen offset:3072 nt lds
  v_mov_b32 v124, 0
  v_mov_b32 v125, 0
  v_mov_b32 v126, 0
  v_mov_b32 v127, 0
  v_mov_b32 v128, 0
  v_mov_b32 v129, 0
  s_cmp_ge_u32 s39, s47
  v_mov_b32 v130, 0
  v_mov_b32 v131, 0
  v_mov_b32 v132, 0
  v_mov_b32 v133, 0
  v_mov_b32 v134, 0
  v_mov_b32 v135, 0
  s_cselect_b32 s38, s51, s39
  v_mov_b32 v136, 0
  v_mov_b32 v137, 0
  v_mov_b32 v138, 0
  v_mov_b32 v139, 0
  v_mov_b32 v140, 0
  v_mov_b32 v141, 0
  s_add_u32 m0, s38, 81920
  v_mov_b32 v142, 0
  v_mov_b32 v143, 0
  v_mov_b32 v144, 0
  v_mov_b32 v145, 0
  v_mov_b32 v146, 0
  v_mov_b32 v147, 0
  s_nop 0
  v_mov_b32 v148, 0
  v_mov_b32 v149, 0
  v_mov_b32 v150, 0
  v_mov_b32 v151, 0
  v_mov_b32 v32, 0
  v_mov_b32 v33, 0
  buffer_load_dwordx4 v2, s[8:11], s36 offen offset:0 nt lds
  v_mov_b32 v34, 0
  v_mov_b32 v35, 0
  v_mov_b32 v3, 0xff800000
  v_mov_b32 v24, 0
  v_mov_b32 v168, 0xff800000
  v_mov_b32 v169, 0xff800000
  buffer_load_dwordx4 v2, s[8:11], s36 offen offset:1024 nt lds
  v_mov_b32 v170, 0xff800000
  v_mov_b32 v171, 0xff800000
  v_mov_b32 v172, 0xff800000
  v_mov_b32 v173, 0xff800000
  v_mov_b32 v174, 0xff800000
  v_mov_b32 v175, 0xff800000
  buffer_load_dwordx4 v2, s[8:11], s36 offen offset:2048 nt lds
  v_mov_b32 v176, 0xff800000
  v_mov_b32 v177, 0xff800000
  v_mov_b32 v178, 0xff800000
  v_mov_b32 v179, 0xff800000
  v_mov_b32 v180, 0xff800000
  v_mov_b32 v181, 0xff800000
  buffer_load_dwordx4 v2, s[8:11], s36 offen offset:3072 nt lds
  v_mov_b32 v182, 0xff800000
  v_mov_b32 v183, 0xff800000
  s_mov_b32 s55, 1
  s_mov_b32 s54, 0
  s_mov_b32 s48, 16384
  s_add_u32 s36, s36, 16384
  s_mov_b32 s52, 1000
  s_mov_b32 s12, s90
  s_and_b32 s13, s91, 0xffff
  s_mov_b32 s14, 0x48000
  s_mov_b32 s15, 0x20000
  s_waitcnt lgkmcnt(0)
L_loop:
  s_cmp_gt_u32 s54, 6
  s_cbranch_scc0 L_w24
  s_waitcnt vmcnt(16)
L_w24:
  s_waitcnt vmcnt(24)
  s_barrier
  s_cmp_eq_u32 s54, 6
  s_cbranch_scc1 L_nodma
  ds_read_b128 v[184:187], v12
  ds_read_b128 v[188:191], v13
  ds_read_b128 v[192:195], v14
  ds_read_b128 v[196:199], v15
  ds_read_b128 v[200:203], v16
  ds_read_b128 v[204:207], v17
  ds_read_b128 v[208:211], v18
  ds_read_b128 v[212:215], v19
  s_mov_b32 m0, s38
  s_add_u32 s39, s38, 16384
  buffer_load_dwordx4 v4, s[4:7], s36 offen offset:0 nt lds
  v_fma_f32 v152, v168, s41, -v24
  v_fma_f32 v153, v169, s41, -v24
  v_fma_f32 v154, v170, s41, -v24
  v_fma_f32 v155, v171, s41, -v24
  v_fma_f32 v156, v172, s41, -v24
  v_fma_f32 v157, v173, s41, -v24
  v_fma_f32 v158, v174, s41, -v24
  v_fma_f32 v159, v175, s41, -v24
  v_fma_f32 v160, v176, s41, -v24
  v_fma_f32 v161, v177, s41, -v24
  v_fma_f32 v162, v178, s41, -v24
  v_fma_f32 v163, v179, s41, -v24
  v_fma_f32 v164, v180, s41, -v24
  v_fma_f32 v165, v181, s41, -v24
  v_fma_f32 v166, v182, s41, -v24
  v_fma_f32 v167, v183, s41, -v24
  s_add_u32 s55, s55, 1
  s_cmp_ge_u32 s55, 5
  s_cselect_b32 s100, 0xffff0000, s99
  s_cselect_b32 s55, 0, s55
  s_waitcnt lgkmcnt(7)
  v_mfma_f32_32x32x16_bf16 v[168:183], v[184:187], v[36:39], 0
  ds_read_b64_tr_b16 v[184:185], v22 offset:0
  ds_read_b64_tr_b16 v[186:187], v22 offset:2048
  v_exp_f32 v152, v152
  v_exp_f32 v153, v153
  v_exp_f32 v154, v154
  s_waitcnt lgkmcnt(8)
  v_mfma_f32_32x32x16_bf16 v[168:183], v[188:191], v[40:43], v[168:183]
  ds_read_b64_tr_b16 v[188:189], v23 offset:0
  ds_read_b64_tr_b16 v[190:191], v23 offset:2048
  v_exp_f32 v155, v155
  v_cvt_pk_bf16_f32 v152, v152, v153
  v_exp_f32 v156, v156
  s_waitcnt lgkmcnt(9)
  v_mfma_f32_32x32x16_bf16 v[168:183], v[192:195], v[44:47], v[168:183]
  ds_read_b64_tr_b16 v[192:193], v22 offset:4096
  ds_read_b64_tr_b16 v[194:195], v22 offset:6144
  v_exp_f32 v157, v157
  v_cvt_pk_bf16_f32 v153, v154, v155
  v_exp_f32 v158, v158
  s_waitcnt lgkmcnt(10)
  v_mfma_f32_32x32x16_bf16 v[168:183], v[196:199], v[48:51], v[168:183]
  ds_read_b64_tr_b16 v[196:197], v23 offset:4096
  ds_read_b64_tr_b16 v[198:199], v23 offset:6144
  v_exp_f32 v159, v159
  v_cvt_pk_bf16_f32 v154, v156, v157
  v_exp_f32 v160, v160
  buffer_load_dwordx4 v5, s[4:7], s36 offen offset:1024 nt lds
  s_waitcnt lgkmcnt(11)
  v_mfma_f32_32x32x16_bf16 v[168:183], v[200:203], v[52:55], v[168:183]
  ds_read_b64_tr_b16 v[200:201], v20 offset:0
  ds_read_b64_tr_b16 v[202:203], v20 offset:2048
  v_exp_f32 v161, v161
  v_cvt_pk_bf16_f32 v155, v158, v159
  v_exp_f32 v162, v162
  s_waitcnt lgkmcnt(12)
  v_mfma_f32_32x32x16_bf16 v[168:183], v[204:207], v[56:59], v[168:183]
  ds_read_b64_tr_b16 v[204:205], v21 offset:0
  ds_read_b64_tr_b16 v[206:207], v21 offset:2048
  v_exp_f32 v163, v163
  v_cvt_pk_bf16_f32 v156, v160, v161
  v_exp_f32 v164, v164
  s_waitcnt lgkmcnt(13)
  v_mfma_f32_32x32x16_bf16 v[168:183], v[208:211], v[60:63], v[168:183]
  ds_read_b64_tr_b16 v[208:209], v20 offset:4096
  ds_read_b64_tr_b16 v[210:211], v20 offset:6144
  v_exp_f32 v165, v165
  v_cvt_pk_bf16_f32 v157, v162, v163
  v_exp_f32 v166, v166
  v_exp_f32 v167, v167
  s_waitcnt lgkmcnt(14)
  v_mfma_f32_32x32x16_bf16 v[168:183], v[212:215], v[64:67], v[168:183]
  v_cvt_pk_bf16_f32 v158, v164, v165
  s_nop 0
  v_cvt_pk_bf16_f32 v159, v166, v167
  s_waitcnt lgkmcnt(12)
  ds_read_b64_tr_b16 v[212:213], v21 offset:4096
  ds_read_b64_tr_b16 v[214:215], v21 offset:6144
  v_mfma_f32_32x32x16_bf16 v[120:135], v[184:187], v[152:155], v[120:135]
  buffer_load_dwordx4 v6, s[4:7], s36 offen offset:2048 nt lds
  v_add_u32 v12, s48, v12
  v_add_u32 v13, s48, v13
  v_add_u32 v14, s48, v14
  s_waitcnt lgkmcnt(10)
  v_mfma_f32_32x32x16_bf16 v[136:151], v[188:191], v[152:155], v[136:151]
  v_add_u32 v15, s48, v15
  v_add_u32 v16, s48, v16
  v_add_u32 v17, s48, v17
  v_add_u32 v18, s48, v18
  v_add_u32 v19, s48, v19
  v_mfma_f32_32x32x16_bf16 v[120:135], v[192:195], v[156:159], v[120:135]
  buffer_load_dwordx4 v7, s[4:7], s36 offen offset:3072 nt lds
  s_cmp_ge_u32 s39, s47
  s_cselect_b32 s38, s51, s39
  s_add_u32 m0, s38, 81920
  v_add_u32 v20, s100, v20
  v_add_u32 v21, s100, v21
  s_waitcnt lgkmcnt(6)
  v_mfma_f32_32x32x16_bf16 v[136:151], v[196:199], v[156:159], v[136:151]
  v_add_u32 v22, s100, v22
  v_add_u32 v23, s100, v23
  v_max3_f32 v25, v168, v169, v170
  v_max3_f32 v8, v171, v172, v173
  v_max3_f32 v25, v25, v174, v175
  v_mfma_f32_32x32x16_bf16 v[88:103], v[200:203], v[152:155], v[88:103]
  buffer_load_dwordx4 v2, s[8:11], s36 offen offset:0 nt lds
  v_max3_f32 v8, v8, v176, v177
  v_max3_f32 v25, v25, v178, v179
  v_max3_f32 v8, v8, v180, v181
  s_waitcnt lgkmcnt(2)
  v_mfma_f32_32x32x16_bf16 v[104:119], v[204:207], v[152:155], v[104:119]
  v_max3_f32 v25, v25, v182, v183
  v_max_f32 v25, v25, v8
  v_mov_b32 v8, v25
  buffer_load_dwordx4 v2, s[8:11], s36 offen offset:1024 nt lds
  s_mov_b32 s48, s100
  v_mfma_f32_32x32x16_bf16 v[88:103], v[208:211], v[156:159], v[88:103]
  v_permlane32_swap_b32 v25, v8
  buffer_load_dwordx4 v2, s[8:11], s36 offen offset:2048 nt lds
  s_nop 0
  v_max_f32 v25, v25, v8
  v_sub_f32 v8, v25, v3
  s_waitcnt lgkmcnt(0)
  v_mfma_f32_32x32x16_bf16 v[104:119], v[212:215], v[156:159], v[104:119]
  buffer_load_dwordx4 v2, s[8:11], s36 offen offset:3072 nt lds
  v_cmp_lt_f32 vcc, s98, v8
  v_mfma_f32_16x16x32_bf16 v[32:35], v[28:31], v[152:155], v[32:35]
  v_mfma_f32_16x16x32_bf16 v[32:35], v[28:31], v[156:159], v[32:35]
  s_add_u32 s36, s36, 16384
  s_cbranch_vccz L_norsm
  s_call_b64 s[96:97], L_rescale
L_norsm:
L_loop_end:
  s_cmp_eq_u32 s54, s52
  s_cbranch_scc1 L_special
L_special_ret:
  s_add_u32 s54, s54, 1
  s_add_u32 s44, s54, 2
  s_cmp_lt_u32 s44, s53
  s_cbranch_scc1 L_loop
  v_add_u32 v4, 131072, v4
  v_add_u32 v5, 131072, v5
  v_add_u32 v6, 131072, v6
  v_add_u32 v7, 131072, v7
  s_lshl_b32 s49, s35, 2
  s_add_u32 s49, s49, s32
  s_mul_i32 s49, s49, 6144
  s_add_u32 s49, s49, 4194304
  s_cmp_lt_u32 s2, 128
  s_cselect_b32 s52, 0x7ff00000, s49
  s_add_u32 s40, s52, 4096
  s_add_u32 s37, s52, 8192
  s_waitcnt vmcnt(16)
  s_barrier
  ds_read_b128 v[184:187], v12
  ds_read_b128 v[188:191], v13
  ds_read_b128 v[192:195], v14
  ds_read_b128 v[196:199], v15
  ds_read_b128 v[200:203], v16
  ds_read_b128 v[204:207], v17
  ds_read_b128 v[208:211], v18
  ds_read_b128 v[212:215], v19
  s_mov_b32 m0, s38
  s_add_u32 s39, s38, 16384
  buffer_load_dwordx4 v4, s[4:7], s36 offen offset:0 nt lds
  v_fma_f32 v152, v168, s41, -v24
  v_fma_f32 v153, v169, s41, -v24
  v_fma_f32 v154, v170, s41, -v24
  v_fma_f32 v155, v171, s41, -v24
  v_fma_f32 v156, v172, s41, -v24
  v_fma_f32 v157, v173, s41, -v24
  v_fma_f32 v158, v174, s41, -v24
  v_fma_f32 v159, v175, s41, -v24
  v_fma_f32 v160, v176, s41, -v24
  v_fma_f32 v161, v177, s41, -v24
  v_fma_f32 v162, v178, s41, -v24
  v_fma_f32 v163, v179, s41, -v24
  v_fma_f32 v164, v180, s41, -v24
  v_fma_f32 v165, v181, s41, -v24
  v_fma_f32 v166, v182, s41, -v24
  v_fma_f32 v167, v183, s41, -v24
  s_add_u32 s55, s55, 1
  s_cmp_ge_u32 s55, 5
  s_cselect_b32 s100, 0xffff0000, s99
  s_cselect_b32 s55, 0, s55
  s_waitcnt lgkmcnt(7)
  v_mfma_f32_32x32x16_bf16 v[168:183], v[184:187], v[36:39], 0
  ds_read_b64_tr_b16 v[184:185], v22 offset:0
  ds_read_b64_tr_b16 v[186:187], v22 offset:2048
  v_exp_f32 v152, v152
  v_exp_f32 v153, v153
  v_exp_f32 v154, v154
  s_waitcnt lgkmcnt(8)
  v_mfma_f32_32x32x16_bf16 v[168:183], v[188:191], v[40:43], v[168:183]
  ds_read_b64_tr_b16 v[188:189], v23 offset:0
  ds_read_b64_tr_b16 v[190:191], v23 offset:2048
  v_exp_f32 v155, v155
  v_cvt_pk_bf16_f32 v152, v152, v153
  v_exp_f32 v156, v156
  s_waitcnt lgkmcnt(9)
  v_mfma_f32_32x32x16_bf16 v[168:183], v[192:195], v[44:47], v[168:183]
  ds_read_b64_tr_b16 v[192:193], v22 offset:4096
  ds_read_b64_tr_b16 v[194:195], v22 offset:6144
  v_exp_f32 v157, v157
  v_cvt_pk_bf16_f32 v153, v154, v155
  v_exp_f32 v158, v158
  s_waitcnt lgkmcnt(10)
  v_mfma_f32_32x32x16_bf16 v[168:183], v[196:199], v[48:51], v[168:183]
  ds_read_b64_tr_b16 v[196:197], v23 offset:4096
  ds_read_b64_tr_b16 v[198:199], v23 offset:6144
  v_exp_f32 v159, v159
  v_cvt_pk_bf16_f32 v154, v156, v157
  v_exp_f32 v160, v160
  buffer_load_dwordx4 v5, s[4:7], s36 offen offset:1024 nt lds
  s_waitcnt lgkmcnt(11)
  v_mfma_f32_32x32x16_bf16 v[168:183], v[200:203], v[52:55], v[168:183]
  ds_read_b64_tr_b16 v[200:201], v20 offset:0
  ds_read_b64_tr_b16 v[202:203], v20 offset:2048
  v_exp_f32 v161, v161
  v_cvt_pk_bf16_f32 v155, v158, v159
  v_exp_f32 v162, v162
  s_waitcnt lgkmcnt(12)
  v_mfma_f32_32x32x16_bf16 v[168:183], v[204:207], v[56:59], v[168:183]
  ds_read_b64_tr_b16 v[204:205], v21 offset:0
  ds_read_b64_tr_b16 v[206:207], v21 offset:2048
  v_exp_f32 v163, v163
  v_cvt_pk_bf16_f32 v156, v160, v161
  v_exp_f32 v164, v164
  s_waitcnt lgkmcnt(13)
  v_mfma_f32_32x32x16_bf16 v[168:183], v[208:211], v[60:63], v[168:183]
  ds_read_b64_tr_b16 v[208:209], v20 offset:4096
  ds_read_b64_tr_b16 v[210:211], v20 offset:6144
  v_exp_f32 v165, v165
  v_cvt_pk_bf16_f32 v157, v162, v163
  v_exp_f32 v166, v166
  v_exp_f32 v167, v167
  s_waitcnt lgkmcnt(14)
  v_mfma_f32_32x32x16_bf16 v[168:183], v[212:215], v[64:67], v[168:183]
  v_cvt_pk_bf16_f32 v158, v164, v165
  s_nop 0
  v_cvt_pk_bf16_f32 v159, v166, v167
  s_waitcnt lgkmcnt(12)
  ds_read_b64_tr_b16 v[212:213], v21 offset:4096
  ds_read_b64_tr_b16 v[214:215], v21 offset:6144
  v_mfma_f32_32x32x16_bf16 v[120:135], v[184:187], v[152:155], v[120:135]
  buffer_load_dwordx4 v6, s[4:7], s36 offen offset:2048 nt lds
  v_add_u32 v12, s48, v12
  v_add_u32 v13, s48, v13
  v_add_u32 v14, s48, v14
  s_waitcnt lgkmcnt(10)
  v_mfma_f32_32x32x16_bf16 v[136:151], v[188:191], v[152:155], v[136:151]
  v_add_u32 v15, s48, v15
  v_add_u32 v16, s48, v16
  v_add_u32 v17, s48, v17
  v_add_u32 v18, s48, v18
  v_add_u32 v19, s48, v19
  v_mfma_f32_32x32x16_bf16 v[120:135], v[192:195], v[156:159], v[120:135]
  buffer_load_dwordx4 v7, s[4:7], s36 offen offset:3072 nt lds
  v_add_u32 v20, s100, v20
  v_add_u32 v21, s100, v21
  s_waitcnt lgkmcnt(6)
  v_mfma_f32_32x32x16_bf16 v[136:151], v[196:199], v[156:159], v[136:151]
  v_add_u32 v22, s100, v22
  v_add_u32 v23, s100, v23
  v_max3_f32 v25, v168, v169, v170
  v_max3_f32 v8, v171, v172, v173
  v_max3_f32 v25, v25, v174, v175
  v_mfma_f32_32x32x16_bf16 v[88:103], v[200:203], v[152:155], v[88:103]
  v_max3_f32 v8, v8, v176, v177
  v_max3_f32 v25, v25, v178, v179
  v_max3_f32 v8, v8, v180, v181
  s_waitcnt lgkmcnt(2)
  v_mfma_f32_32x32x16_bf16 v[104:119], v[204:207], v[152:155], v[104:119]
  v_max3_f32 v25, v25, v182, v183
  v_max_f32 v25, v25, v8
  v_mov_b32 v8, v25
  s_mov_b32 s48, s100
  v_mfma_f32_32x32x16_bf16 v[88:103], v[208:211], v[156:159], v[88:103]
  v_permlane32_swap_b32 v25, v8
  s_nop 0
  v_max_f32 v25, v25, v8
  v_sub_f32 v8, v25, v3
  s_waitcnt lgkmcnt(0)
  v_mfma_f32_32x32x16_bf16 v[104:119], v[212:215], v[156:159], v[104:119]
  v_cmp_lt_f32 vcc, s98, v8
  v_mfma_f32_16x16x32_bf16 v[32:35], v[28:31], v[152:155], v[32:35]
  v_mfma_f32_16x16x32_bf16 v[32:35], v[28:31], v[156:159], v[32:35]
  s_add_u32 s54, s54, 1
  s_cbranch_vccz L_norsd1
  s_call_b64 s[96:97], L_rescale
L_norsd1:
  s_waitcnt vmcnt(12)
  s_barrier
  ds_read_b128 v[184:187], v12
  ds_read_b128 v[188:191], v13
  ds_read_b128 v[192:195], v14
  ds_read_b128 v[196:199], v15
  ds_read_b128 v[200:203], v16
  ds_read_b128 v[204:207], v17
  ds_read_b128 v[208:211], v18
  ds_read_b128 v[212:215], v19
  buffer_load_dwordx4 v[216:219], v1, s[20:23], s52 offen offset:0 sc1
  v_fma_f32 v152, v168, s41, -v24
  v_fma_f32 v153, v169, s41, -v24
  v_fma_f32 v154, v170, s41, -v24
  v_fma_f32 v155, v171, s41, -v24
  v_fma_f32 v156, v172, s41, -v24
  v_fma_f32 v157, v173, s41, -v24
  v_fma_f32 v158, v174, s41, -v24
  v_fma_f32 v159, v175, s41, -v24
  v_fma_f32 v160, v176, s41, -v24
  v_fma_f32 v161, v177, s41, -v24
  v_fma_f32 v162, v178, s41, -v24
  v_fma_f32 v163, v179, s41, -v24
  v_fma_f32 v164, v180, s41, -v24
  v_fma_f32 v165, v181, s41, -v24
  v_fma_f32 v166, v182, s41, -v24
  v_fma_f32 v167, v183, s41, -v24
  s_add_u32 s55, s55, 1
  s_cmp_ge_u32 s55, 5
  s_cselect_b32 s100, 0xffff0000, s99
  s_cselect_b32 s55, 0, s55
  s_waitcnt lgkmcnt(7)
  v_mfma_f32_32x32x16_bf16 v[168:183], v[184:187], v[36:39], 0
  ds_read_b64_tr_b16 v[184:185], v22 offset:0
  ds_read_b64_tr_b16 v[186:187], v22 offset:2048
  v_exp_f32 v152, v152
  v_exp_f32 v153, v153
  v_exp_f32 v154, v154
  s_waitcnt lgkmcnt(8)
  v_mfma_f32_32x32x16_bf16 v[168:183], v[188:191], v[40:43], v[168:183]
  ds_read_b64_tr_b16 v[188:189], v23 offset:0
  ds_read_b64_tr_b16 v[190:191], v23 offset:2048
  v_exp_f32 v155, v155
  v_cvt_pk_bf16_f32 v152, v152, v153
  v_exp_f32 v156, v156
  s_waitcnt lgkmcnt(9)
  v_mfma_f32_32x32x16_bf16 v[168:183], v[192:195], v[44:47], v[168:183]
  ds_read_b64_tr_b16 v[192:193], v22 offset:4096
  ds_read_b64_tr_b16 v[194:195], v22 offset:6144
  v_exp_f32 v157, v157
  v_cvt_pk_bf16_f32 v153, v154, v155
  v_exp_f32 v158, v158
  s_waitcnt lgkmcnt(10)
  v_mfma_f32_32x32x16_bf16 v[168:183], v[196:199], v[48:51], v[168:183]
  ds_read_b64_tr_b16 v[196:197], v23 offset:4096
  ds_read_b64_tr_b16 v[198:199], v23 offset:6144
  v_exp_f32 v159, v159
  v_cvt_pk_bf16_f32 v154, v156, v157
  v_exp_f32 v160, v160
  buffer_load_dwordx4 v[220:223], v1, s[20:23], s52 offen offset:1024 sc1
  s_waitcnt lgkmcnt(11)
  v_mfma_f32_32x32x16_bf16 v[168:183], v[200:203], v[52:55], v[168:183]
  ds_read_b64_tr_b16 v[200:201], v20 offset:0
  ds_read_b64_tr_b16 v[202:203], v20 offset:2048
  v_exp_f32 v161, v161
  v_cvt_pk_bf16_f32 v155, v158, v159
  v_exp_f32 v162, v162
  s_waitcnt lgkmcnt(12)
  v_mfma_f32_32x32x16_bf16 v[168:183], v[204:207], v[56:59], v[168:183]
  ds_read_b64_tr_b16 v[204:205], v21 offset:0
  ds_read_b64_tr_b16 v[206:207], v21 offset:2048
  v_exp_f32 v163, v163
  v_cvt_pk_bf16_f32 v156, v160, v161
  v_exp_f32 v164, v164
  s_waitcnt lgkmcnt(13)
  v_mfma_f32_32x32x16_bf16 v[168:183], v[208:211], v[60:63], v[168:183]
  ds_read_b64_tr_b16 v[208:209], v20 offset:4096
  ds_read_b64_tr_b16 v[210:211], v20 offset:6144
  v_exp_f32 v165, v165
  v_cvt_pk_bf16_f32 v157, v162, v163
  v_exp_f32 v166, v166
  v_exp_f32 v167, v167
  s_waitcnt lgkmcnt(14)
  v_mfma_f32_32x32x16_bf16 v[168:183], v[212:215], v[64:67], v[168:183]
  v_cvt_pk_bf16_f32 v158, v164, v165
  s_nop 0
  v_cvt_pk_bf16_f32 v159, v166, v167
  s_waitcnt lgkmcnt(12)
  ds_read_b64_tr_b16 v[212:213], v21 offset:4096
  ds_read_b64_tr_b16 v[214:215], v21 offset:6144
  v_mfma_f32_32x32x16_bf16 v[120:135], v[184:187], v[152:155], v[120:135]
  buffer_load_dwordx4 v[224:227], v1, s[20:23], s52 offen offset:2048 sc1
  v_add_u32 v12, s48, v12
  v_add_u32 v13, s48, v13
  v_add_u32 v14, s48, v14
  s_waitcnt lgkmcnt(10)
  v_mfma_f32_32x32x16_bf16 v[136:151], v[188:191], v[152:155], v[136:151]
  v_add_u32 v15, s48, v15
  v_add_u32 v16, s48, v16
  v_add_u32 v17, s48, v17
  v_add_u32 v18, s48, v18
  v_add_u32 v19, s48, v19
  v_mfma_f32_32x32x16_bf16 v[120:135], v[192:195], v[156:159], v[120:135]
  buffer_load_dwordx4 v[228:231], v1, s[20:23], s52 offen offset:3072 sc1
  v_add_u32 v20, s100, v20
  v_add_u32 v21, s100, v21
  s_waitcnt lgkmcnt(6)
  v_mfma_f32_32x32x16_bf16 v[136:151], v[196:199], v[156:159], v[136:151]
  v_add_u32 v22, s100, v22
  v_add_u32 v23, s100, v23
  v_max3_f32 v25, v168, v169, v170
  v_max3_f32 v8, v171, v172, v173
  v_max3_f32 v25, v25, v174, v175
  v_mfma_f32_32x32x16_bf16 v[88:103], v[200:203], v[152:155], v[88:103]
  buffer_load_dwordx4 v[232:235], v1, s[20:23], s40 offen offset:0 sc1
  v_max3_f32 v8, v8, v176, v177
  v_max3_f32 v25, v25, v178, v179
  v_max3_f32 v8, v8, v180, v181
  s_waitcnt lgkmcnt(2)
  v_mfma_f32_32x32x16_bf16 v[104:119], v[204:207], v[152:155], v[104:119]
  v_max3_f32 v25, v25, v182, v183
  v_max_f32 v25, v25, v8
  v_mov_b32 v8, v25
  buffer_load_dwordx4 v[236:239], v1, s[20:23], s40 offen offset:1024 sc1
  s_mov_b32 s48, s100
  v_mfma_f32_32x32x16_bf16 v[88:103], v[208:211], v[156:159], v[88:103]
  v_permlane32_swap_b32 v25, v8
  s_nop 0
  v_max_f32 v25, v25, v8
  v_sub_f32 v8, v25, v3
  s_waitcnt lgkmcnt(0)
  v_mfma_f32_32x32x16_bf16 v[104:119], v[212:215], v[156:159], v[104:119]
  v_cmp_lt_f32 vcc, s98, v8
  v_mfma_f32_16x16x32_bf16 v[32:35], v[28:31], v[152:155], v[32:35]
  v_mfma_f32_16x16x32_bf16 v[32:35], v[28:31], v[156:159], v[32:35]
  s_add_u32 s54, s54, 1
  s_cbranch_vccz L_norsd2
  s_call_b64 s[96:97], L_rescale
L_norsd2:
  s_sub_u32 s38, s38, s51
  s_add_u32 s26, s38, 16384
  s_cmp_ge_u32 s26, 81920
  s_cselect_b32 s26, 0, s26
  s_add_u32 s27, s26, 16384
  s_cmp_ge_u32 s27, 81920
  s_cselect_b32 s27, 0, s27
  s_add_u32 s39, s27, 16384
  s_cmp_ge_u32 s39, 81920
  s_cselect_b32 s39, 0, s39
  s_add_u32 s47, s39, 16384
  s_cmp_ge_u32 s47, 81920
  s_cselect_b32 s47, 0, s47
  s_lshl_b32 s44, s32, 9
  s_add_u32 s44, s44, s39
  s_add_u32 s44, s44, 81920
  v_lshrrev_b32 v10, 2, v1
  v_add_u32 v10, s44, v10
  ds_write_b32 v10, v3
  v_xor_b32 v9, 512, v10
  s_waitcnt lgkmcnt(0)
  s_barrier
  ds_read_b32 v25, v9
  s_cmp_lt_u32 s32, 2
  s_cselect_b32 s45, s26, s27
  s_lshl_b32 s46, s101, 13
  s_add_u32 s45, s45, s46
  s_xor_b32 s46, s45, 8192
  v_add_u32 v11, s46, v1
  v_add_u32 v70, s45, v1
  v_and_b32 v68, 1, v253
  v_lshlrev_b32 v68, 12, v68
  v_lshrrev_b32 v69, 1, v253
  v_lshl_add_u32 v68, v69, 8, v68
  v_lshl_add_u32 v68, v254, 4, v68
  s_lshr_b32 s44, s32, 1
  s_lshl_b32 s44, s44, 13
  s_lshl_b32 s45, s101, 11
  s_add_u32 s44, s44, s45
  s_add_u32 s44, s44, s39
  v_add_u32 v68, s44, v68
  s_waitcnt lgkmcnt(0)
  v_cmp_gt_f32 vcc, v25, v3
  s_cbranch_vccz L_magreed
  s_call_b64 s[96:97], L_rescale
L_magreed:
  v_fma_f32 v152, v168, s41, -v24
  v_fma_f32 v153, v169, s41, -v24
  v_fma_f32 v154, v170, s41, -v24
  v_fma_f32 v155, v171, s41, -v24
  v_fma_f32 v156, v172, s41, -v24
  v_fma_f32 v157, v173, s41, -v24
  v_fma_f32 v158, v174, s41, -v24
  v_fma_f32 v159, v175, s41, -v24
  v_fma_f32 v160, v176, s41, -v24
  v_fma_f32 v161, v177, s41, -v24
  v_fma_f32 v162, v178, s41, -v24
  v_fma_f32 v163, v179, s41, -v24
  v_fma_f32 v164, v180, s41, -v24
  v_fma_f32 v165, v181, s41, -v24
  v_fma_f32 v166, v182, s41, -v24
  v_fma_f32 v167, v183, s41, -v24
  v_exp_f32 v152, v152
  v_exp_f32 v153, v153
  v_exp_f32 v154, v154
  v_exp_f32 v155, v155
  v_cvt_pk_bf16_f32 v152, v152, v153
  v_exp_f32 v156, v156
  v_exp_f32 v157, v157
  v_cvt_pk_bf16_f32 v153, v154, v155
  v_exp_f32 v158, v158
  v_exp_f32 v159, v159
  v_cvt_pk_bf16_f32 v154, v156, v157
  v_exp_f32 v160, v160
  v_exp_f32 v161, v161
  v_cvt_pk_bf16_f32 v155, v158, v159
  v_exp_f32 v162, v162
  v_exp_f32 v163, v163
  v_cvt_pk_bf16_f32 v156, v160, v161
  v_exp_f32 v164, v164
  v_exp_f32 v165, v165
  v_cvt_pk_bf16_f32 v157, v162, v163
  v_exp_f32 v166, v166
  v_exp_f32 v167, v167
  v_cvt_pk_bf16_f32 v158, v164, v165
  s_nop 0
  v_cvt_pk_bf16_f32 v159, v166, v167
  s_nop 0
  v_mfma_f32_16x16x32_bf16 v[32:35], v[28:31], v[152:155], v[32:35]
  v_mfma_f32_16x16x32_bf16 v[32:35], v[28:31], v[156:159], v[32:35]
  v_lshrrev_b32 v12, 1, v253
  v_lshlrev_b32 v12, 2, v12
  v_and_b32 v13, 1, v253
  v_add_u32 v12, v12, v13
  v_lshrrev_b32 v13, 2, v254
  v_lshl_add_u32 v12, v12, 2, v13
  v_and_b32 v13, 3, v254
  v_lshlrev_b32 v13, 3, v13
  ds_write_b32 v10, v32 offset:256
  v_lshl_add_u32 v12, v12, 7, v13
  s_lshl_b32 s45, s32, 5
  s_add_u32 s46, s45, s38
  s_add_u32 s45, s45, s47
  v_add_u32 v13, s46, v12
  v_add_u32 v12, s45, v12
  v_add_u32 v14, s39, v1
  v_mov_b32 v15, s28
  s_and_b32 s46, s2, 15
  s_lshl_b32 s44, s34, 4
  s_add_u32 s44, s44, s46
  s_mul_i32 s44, s44, 36864
  s_mul_i32 s45, s32, 9216
  s_add_u32 s44, s44, s45
  s_add_u32 s50, s44, 16777216
  s_waitcnt lgkmcnt(0)
  s_waitcnt vmcnt(6)
  s_barrier
  ds_read_b32 v8, v9 offset:256
  ds_read_b64_tr_b16 v[184:185], v22 offset:0
  ds_read_b64_tr_b16 v[186:187], v22 offset:2048
  ds_read_b64_tr_b16 v[188:189], v23 offset:0
  ds_read_b64_tr_b16 v[190:191], v23 offset:2048
  ds_read_b64_tr_b16 v[192:193], v22 offset:4096
  ds_read_b64_tr_b16 v[194:195], v22 offset:6144
  ds_read_b64_tr_b16 v[196:197], v23 offset:4096
  ds_read_b64_tr_b16 v[198:199], v23 offset:6144
  ds_read_b64_tr_b16 v[200:201], v20 offset:0
  ds_read_b64_tr_b16 v[202:203], v20 offset:2048
  ds_read_b64_tr_b16 v[204:205], v21 offset:0
  ds_read_b64_tr_b16 v[206:207], v21 offset:2048
  ds_read_b64_tr_b16 v[208:209], v20 offset:4096
  ds_read_b64_tr_b16 v[210:211], v20 offset:6144
  s_cmp_lt_u32 s2, 128
  s_waitcnt lgkmcnt(10)
  v_mfma_f32_32x32x16_bf16 v[120:135], v[184:187], v[152:155], v[120:135]
  ds_read_b64_tr_b16 v[212:213], v21 offset:4096
  ds_read_b64_tr_b16 v[214:215], v21 offset:6144
  v_add_f32 v71, v32, v8
  v_mfma_f32_32x32x16_bf16 v[136:151], v[188:191], v[152:155], v[136:151]
  s_waitcnt vmcnt(0)
  s_cbranch_scc1 L_g2_tail
  v_xor_b32 v219, v219, v15
  v_xor_b32 v223, v223, v15
  v_xor_b32 v227, v227, v15
  v_xor_b32 v231, v231, v15
  v_xor_b32 v235, v235, v15
  s_waitcnt lgkmcnt(8)
  v_mfma_f32_32x32x16_bf16 v[120:135], v[192:195], v[156:159], v[120:135]
  v_xor_b32 v239, v239, v15
  v_or3_b32 v219, v219, v223, v227
  v_or3_b32 v231, v231, v235, v239
  v_or_b32 v219, v219, v231
  v_cmp_ne_u32 vcc, 0, v219
  v_max_f32 v25, v3, v237
  v_mfma_f32_32x32x16_bf16 v[136:151], v[196:199], v[156:159], v[136:151]
  v_mul_f32 v24, s41, v25
  v_fma_f32 v26, v3, s41, -v24
  v_fma_f32 v27, v237, s41, -v24
  v_exp_f32 v26, v26
  v_exp_f32 v27, v27
  v_and_b32 v37, 0xffff0000, v216
  s_waitcnt lgkmcnt(4)
  v_mfma_f32_32x32x16_bf16 v[88:103], v[200:203], v[152:155], v[88:103]
  v_lshlrev_b32 v36, 16, v216
  v_mul_f32 v25, v27, v238
  v_fma_f32 v25, v26, v71, v25
  v_rcp_f32 v25, v25
  v_and_b32 v39, 0xffff0000, v217
  v_lshlrev_b32 v38, 16, v217
  v_mfma_f32_32x32x16_bf16 v[104:119], v[204:207], v[152:155], v[104:119]
  s_waitcnt lgkmcnt(0)
  ds_write_b128 v11, v[120:123] offset:0
  ds_write_b128 v11, v[124:127] offset:1024
  ds_write_b128 v11, v[128:131] offset:2048
  ds_write_b128 v11, v[132:135] offset:3072
  v_and_b32 v41, 0xffff0000, v218
  v_lshlrev_b32 v40, 16, v218
  v_mfma_f32_32x32x16_bf16 v[88:103], v[208:211], v[156:159], v[88:103]
  ds_write_b128 v11, v[136:139] offset:4096
  ds_write_b128 v11, v[140:143] offset:5120
  ds_write_b128 v11, v[144:147] offset:6144
  ds_write_b128 v11, v[148:151] offset:7168
  v_and_b32 v43, 0xffff0000, v220
  v_lshlrev_b32 v42, 16, v220
  v_mfma_f32_32x32x16_bf16 v[104:119], v[212:215], v[156:159], v[104:119]
  v_and_b32 v45, 0xffff0000, v221
  v_lshlrev_b32 v44, 16, v221
  v_and_b32 v47, 0xffff0000, v222
  v_lshlrev_b32 v46, 16, v222
  v_and_b32 v49, 0xffff0000, v224
  v_lshlrev_b32 v48, 16, v224
  v_and_b32 v51, 0xffff0000, v225
  v_lshlrev_b32 v50, 16, v225
  v_and_b32 v53, 0xffff0000, v226
  v_lshlrev_b32 v52, 16, v226
  v_and_b32 v55, 0xffff0000, v228
  v_lshlrev_b32 v54, 16, v228
  v_and_b32 v57, 0xffff0000, v229
  v_lshlrev_b32 v56, 16, v229
  v_and_b32 v59, 0xffff0000, v230
  v_lshlrev_b32 v58, 16, v230
  v_and_b32 v61, 0xffff0000, v232
  v_lshlrev_b32 v60, 16, v232
  v_and_b32 v63, 0xffff0000, v233
  v_lshlrev_b32 v62, 16, v233
  v_and_b32 v65, 0xffff0000, v234
  v_lshlrev_b32 v64, 16, v234
  v_and_b32 v67, 0xffff0000, v236
  v_lshlrev_b32 v66, 16, v236
  v_mul_f32 v26, v26, v25
  v_mul_f32 v27, v27, v25
  v_mul_f32 v36, v36, v27
  v_mul_f32 v37, v37, v27
  v_mul_f32 v38, v38, v27
  v_mul_f32 v39, v39, v27
  v_mul_f32 v40, v40, v27
  v_mul_f32 v41, v41, v27
  v_mul_f32 v42, v42, v27
  v_mul_f32 v43, v43, v27
  v_mul_f32 v44, v44, v27
  v_mul_f32 v45, v45, v27
  v_mul_f32 v46, v46, v27
  v_mul_f32 v47, v47, v27
  v_mul_f32 v48, v48, v27
  v_mul_f32 v49, v49, v27
  v_mul_f32 v50, v50, v27
  v_mul_f32 v51, v51, v27
  v_mul_f32 v52, v52, v27
  v_mul_f32 v53, v53, v27
  v_mul_f32 v54, v54, v27
  v_mul_f32 v55, v55, v27
  v_mul_f32 v56, v56, v27
  v_mul_f32 v57, v57, v27
  v_mul_f32 v58, v58, v27
  v_mul_f32 v59, v59, v27
  v_mul_f32 v60, v60, v27
  v_mul_f32 v61, v61, v27
  v_mul_f32 v62, v62, v27
  v_mul_f32 v63, v63, v27
  v_mul_f32 v64, v64, v27
  v_mul_f32 v65, v65, v27
  v_mul_f32 v66, v66, v27
  v_mul_f32 v67, v67, v27
  s_cbranch_vccnz L_pollo
L_pollo_done:
  s_waitcnt lgkmcnt(0)
  s_barrier
  ds_read_b128 v[120:123], v70 offset:0
  ds_read_b128 v[124:127], v70 offset:1024
  ds_read_b128 v[128:131], v70 offset:2048
  ds_read_b128 v[132:135], v70 offset:3072
  ds_read_b128 v[136:139], v70 offset:4096
  ds_read_b128 v[140:143], v70 offset:5120
  ds_read_b128 v[144:147], v70 offset:6144
  ds_read_b128 v[148:151], v70 offset:7168
  s_waitcnt lgkmcnt(6)
  v_pk_add_f32 v[88:89], v[88:89], v[120:121]
  v_pk_add_f32 v[90:91], v[90:91], v[122:123]
  v_pk_add_f32 v[92:93], v[92:93], v[124:125]
  v_pk_add_f32 v[94:95], v[94:95], v[126:127]
  v_pk_fma_f32 v[88:89], v[88:89], v[26:27], v[36:37] op_sel_hi:[1,0,1]
  v_pk_fma_f32 v[90:91], v[90:91], v[26:27], v[38:39] op_sel_hi:[1,0,1]
  v_pk_fma_f32 v[92:93], v[92:93], v[26:27], v[40:41] op_sel_hi:[1,0,1]
  v_pk_fma_f32 v[94:95], v[94:95], v[26:27], v[42:43] op_sel_hi:[1,0,1]
  v_cvt_pk_bf16_f32 v72, v88, v89
  v_cvt_pk_bf16_f32 v73, v90, v91
  v_cvt_pk_bf16_f32 v74, v92, v93
  v_cvt_pk_bf16_f32 v75, v94, v95
  ds_write_b128 v68, v[72:75] offset:0
  s_waitcnt lgkmcnt(5)
  v_pk_add_f32 v[96:97], v[96:97], v[128:129]
  v_pk_add_f32 v[98:99], v[98:99], v[130:131]
  v_pk_add_f32 v[100:101], v[100:101], v[132:133]
  v_pk_add_f32 v[102:103], v[102:103], v[134:135]
  v_pk_fma_f32 v[96:97], v[96:97], v[26:27], v[44:45] op_sel_hi:[1,0,1]
  v_pk_fma_f32 v[98:99], v[98:99], v[26:27], v[46:47] op_sel_hi:[1,0,1]
  v_pk_fma_f32 v[100:101], v[100:101], v[26:27], v[48:49] op_sel_hi:[1,0,1]
  v_pk_fma_f32 v[102:103], v[102:103], v[26:27], v[50:51] op_sel_hi:[1,0,1]
  v_cvt_pk_bf16_f32 v76, v96, v97
  v_cvt_pk_bf16_f32 v77, v98, v99
  v_cvt_pk_bf16_f32 v78, v100, v101
  v_cvt_pk_bf16_f32 v79, v102, v103
  ds_write_b128 v68, v[76:79] offset:512
  s_waitcnt lgkmcnt(4)
  v_pk_add_f32 v[104:105], v[104:105], v[136:137]
  v_pk_add_f32 v[106:107], v[106:107], v[138:139]
  v_pk_add_f32 v[108:109], v[108:109], v[140:141]
  v_pk_add_f32 v[110:111], v[110:111], v[142:143]
  v_pk_fma_f32 v[104:105], v[104:105], v[26:27], v[52:53] op_sel_hi:[1,0,1]
  v_pk_fma_f32 v[106:107], v[106:107], v[26:27], v[54:55] op_sel_hi:[1,0,1]
  v_pk_fma_f32 v[108:109], v[108:109], v[26:27], v[56:57] op_sel_hi:[1,0,1]
  v_pk_fma_f32 v[110:111], v[110:111], v[26:27], v[58:59] op_sel_hi:[1,0,1]
  v_cvt_pk_bf16_f32 v80, v104, v105
  v_cvt_pk_bf16_f32 v81, v106, v107
  v_cvt_pk_bf16_f32 v82, v108, v109
  v_cvt_pk_bf16_f32 v83, v110, v111
  ds_write_b128 v68, v[80:83] offset:1024
  s_waitcnt lgkmcnt(3)
  v_pk_add_f32 v[112:113], v[112:113], v[144:145]
  v_pk_add_f32 v[114:115], v[114:115], v[146:147]
  v_pk_add_f32 v[116:117], v[116:117], v[148:149]
  v_pk_add_f32 v[118:119], v[118:119], v[150:151]
  v_pk_fma_f32 v[112:113], v[112:113], v[26:27], v[60:61] op_sel_hi:[1,0,1]
  v_pk_fma_f32 v[114:115], v[114:115], v[26:27], v[62:63] op_sel_hi:[1,0,1]
  v_pk_fma_f32 v[116:117], v[116:117], v[26:27], v[64:65] op_sel_hi:[1,0,1]
  v_pk_fma_f32 v[118:119], v[118:119], v[26:27], v[66:67] op_sel_hi:[1,0,1]
  v_cvt_pk_bf16_f32 v84, v112, v113
  v_cvt_pk_bf16_f32 v85, v114, v115
  v_cvt_pk_bf16_f32 v86, v116, v117
  v_cvt_pk_bf16_f32 v87, v118, v119
  ds_write_b128 v68, v[84:87] offset:1536
  s_mov_b32 s44, s50
  s_waitcnt lgkmcnt(0)
  s_barrier
  ds_read_b128 v[36:39], v14 offset:0
  ds_read_b64_tr_b16 v[216:217], v12 offset:0
  ds_read_b64_tr_b16 v[218:219], v12 offset:1024
  ds_read_b128 v[40:43], v14 offset:1024
  ds_read_b64_tr_b16 v[220:221], v12 offset:4096
  ds_read_b64_tr_b16 v[222:223], v12 offset:5120
  ds_read_b128 v[44:47], v14 offset:2048
  ds_read_b64_tr_b16 v[224:225], v12 offset:8192
  ds_read_b64_tr_b16 v[226:227], v12 offset:9216
  ds_read_b128 v[48:51], v14 offset:3072
  ds_read_b64_tr_b16 v[228:229], v12 offset:12288
  ds_read_b64_tr_b16 v[230:231], v12 offset:13312
  s_waitcnt lgkmcnt(9)
  v_mfma_f32_16x16x32_bf16 v[144:147], v[36:39], a[0:3], 0
  ds_read_b128 v[52:55], v14 offset:8192
  v_mfma_f32_16x16x32_bf16 v[148:151], v[36:39], a[4:7], 0
  ds_read_b64_tr_b16 v[232:233], v13 offset:0
  v_mfma_f32_16x16x32_bf16 v[152:155], v[36:39], a[8:11], 0
  ds_read_b64_tr_b16 v[234:235], v13 offset:1024
  v_mfma_f32_16x16x32_bf16 v[156:159], v[36:39], a[12:15], 0
  v_mfma_f32_16x16x32_bf16 v[160:163], v[36:39], a[16:19], 0
  v_mfma_f32_16x16x32_bf16 v[164:167], v[36:39], a[20:23], 0
  v_mfma_f32_16x16x32_bf16 v[168:171], v[36:39], a[24:27], 0
  v_mfma_f32_16x16x32_bf16 v[172:175], v[36:39], a[28:31], 0
  v_mfma_f32_16x16x32_bf16 v[176:179], v[36:39], v[216:219], 0
  s_waitcnt lgkmcnt(9)
  v_mfma_f32_16x16x32_bf16 v[144:147], v[40:43], a[32:35], v[144:147]
  ds_read_b128 v[56:59], v14 offset:9216
  v_mfma_f32_16x16x32_bf16 v[148:151], v[40:43], a[36:39], v[148:151]
  ds_read_b64_tr_b16 v[236:237], v13 offset:4096
  v_mfma_f32_16x16x32_bf16 v[152:155], v[40:43], a[40:43], v[152:155]
  ds_read_b64_tr_b16 v[238:239], v13 offset:5120
  v_mfma_f32_16x16x32_bf16 v[156:159], v[40:43], a[44:47], v[156:159]
  v_mfma_f32_16x16x32_bf16 v[160:163], v[40:43], a[48:51], v[160:163]
  v_mfma_f32_16x16x32_bf16 v[164:167], v[40:43], a[52:55], v[164:167]
  v_mfma_f32_16x16x32_bf16 v[168:171], v[40:43], a[56:59], v[168:171]
  v_mfma_f32_16x16x32_bf16 v[172:175], v[40:43], a[60:63], v[172:175]
  v_mfma_f32_16x16x32_bf16 v[176:179], v[40:43], v[220:223], v[176:179]
  s_waitcnt lgkmcnt(9)
  v_mfma_f32_16x16x32_bf16 v[144:147], v[44:47], a[64:67], v[144:147]
  ds_read_b128 v[60:63], v14 offset:10240
  v_mfma_f32_16x16x32_bf16 v[148:151], v[44:47], a[68:71], v[148:151]
  ds_read_b64_tr_b16 v[240:241], v13 offset:8192
  v_mfma_f32_16x16x32_bf16 v[152:155], v[44:47], a[72:75], v[152:155]
  ds_read_b64_tr_b16 v[242:243], v13 offset:9216
  v_mfma_f32_16x16x32_bf16 v[156:159], v[44:47], a[76:79], v[156:159]
  v_mfma_f32_16x16x32_bf16 v[160:163], v[44:47], a[80:83], v[160:163]
  v_mfma_f32_16x16x32_bf16 v[164:167], v[44:47], a[84:87], v[164:167]
  v_mfma_f32_16x16x32_bf16 v[168:171], v[44:47], a[88:91], v[168:171]
  v_mfma_f32_16x16x32_bf16 v[172:175], v[44:47], a[92:95], v[172:175]
  v_mfma_f32_16x16x32_bf16 v[176:179], v[44:47], v[224:227], v[176:179]
  s_waitcnt lgkmcnt(9)
  v_mfma_f32_16x16x32_bf16 v[144:147], v[48:51], a[96:99], v[144:147]
  ds_read_b128 v[64:67], v14 offset:11264
  v_mfma_f32_16x16x32_bf16 v[148:151], v[48:51], a[100:103], v[148:151]
  ds_read_b64_tr_b16 v[244:245], v13 offset:12288
  v_mfma_f32_16x16x32_bf16 v[152:155], v[48:51], a[104:107], v[152:155]
  ds_read_b64_tr_b16 v[246:247], v13 offset:13312
  v_mfma_f32_16x16x32_bf16 v[156:159], v[48:51], a[108:111], v[156:159]
  v_mfma_f32_16x16x32_bf16 v[160:163], v[48:51], a[112:115], v[160:163]
  v_mfma_f32_16x16x32_bf16 v[164:167], v[48:51], a[116:119], v[164:167]
  v_mfma_f32_16x16x32_bf16 v[168:171], v[48:51], a[120:123], v[168:171]
  v_mfma_f32_16x16x32_bf16 v[172:175], v[48:51], a[124:127], v[172:175]
  v_mfma_f32_16x16x32_bf16 v[176:179], v[48:51], v[228:231], v[176:179]
  s_waitcnt lgkmcnt(9)
  v_mfma_f32_16x16x32_bf16 v[144:147], v[52:55], a[128:131], v[144:147]
  ds_read_b128 v[88:91], v14 offset:4096
  v_mfma_f32_16x16x32_bf16 v[148:151], v[52:55], a[132:135], v[148:151]
  ds_read_b128 v[92:95], v14 offset:5120
  v_mfma_f32_16x16x32_bf16 v[152:155], v[52:55], a[136:139], v[152:155]
  ds_read_b128 v[92:95], v14 offset:5120
  v_mfma_f32_16x16x32_bf16 v[156:159], v[52:55], a[140:143], v[156:159]
  v_mfma_f32_16x16x32_bf16 v[160:163], v[52:55], a[144:147], v[160:163]
  v_mfma_f32_16x16x32_bf16 v[164:167], v[52:55], a[148:151], v[164:167]
  v_mfma_f32_16x16x32_bf16 v[168:171], v[52:55], a[152:155], v[168:171]
  v_mfma_f32_16x16x32_bf16 v[172:175], v[52:55], a[156:159], v[172:175]
  v_mfma_f32_16x16x32_bf16 v[176:179], v[52:55], v[232:235], v[176:179]
  s_waitcnt lgkmcnt(9)
  v_mfma_f32_16x16x32_bf16 v[144:147], v[56:59], a[160:163], v[144:147]
  ds_read_b128 v[96:99], v14 offset:6144
  v_mfma_f32_16x16x32_bf16 v[148:151], v[56:59], a[164:167], v[148:151]
  ds_read_b128 v[100:103], v14 offset:7168
  v_mfma_f32_16x16x32_bf16 v[152:155], v[56:59], a[168:171], v[152:155]
  ds_read_b128 v[100:103], v14 offset:7168
  v_mfma_f32_16x16x32_bf16 v[156:159], v[56:59], a[172:175], v[156:159]
  v_mfma_f32_16x16x32_bf16 v[160:163], v[56:59], a[176:179], v[160:163]
  v_mfma_f32_16x16x32_bf16 v[164:167], v[56:59], a[180:183], v[164:167]
  v_mfma_f32_16x16x32_bf16 v[168:171], v[56:59], a[184:187], v[168:171]
  v_mfma_f32_16x16x32_bf16 v[172:175], v[56:59], a[188:191], v[172:175]
  v_mfma_f32_16x16x32_bf16 v[176:179], v[56:59], v[236:239], v[176:179]
  s_waitcnt lgkmcnt(9)
  v_mfma_f32_16x16x32_bf16 v[144:147], v[60:63], a[192:195], v[144:147]
  ds_read_b128 v[104:107], v14 offset:12288
  v_mfma_f32_16x16x32_bf16 v[148:151], v[60:63], a[196:199], v[148:151]
  ds_read_b128 v[108:111], v14 offset:13312
  v_mfma_f32_16x16x32_bf16 v[152:155], v[60:63], a[200:203], v[152:155]
  ds_read_b128 v[108:111], v14 offset:13312
  v_mfma_f32_16x16x32_bf16 v[156:159], v[60:63], a[204:207], v[156:159]
  v_mfma_f32_16x16x32_bf16 v[160:163], v[60:63], a[208:211], v[160:163]
  v_mfma_f32_16x16x32_bf16 v[164:167], v[60:63], a[212:215], v[164:167]
  v_mfma_f32_16x16x32_bf16 v[168:171], v[60:63], a[216:219], v[168:171]
  v_mfma_f32_16x16x32_bf16 v[172:175], v[60:63], a[220:223], v[172:175]
  v_mfma_f32_16x16x32_bf16 v[176:179], v[60:63], v[240:243], v[176:179]
  s_waitcnt lgkmcnt(9)
  v_mfma_f32_16x16x32_bf16 v[144:147], v[64:67], a[224:227], v[144:147]
  ds_read_b128 v[112:115], v14 offset:14336
  v_mfma_f32_16x16x32_bf16 v[148:151], v[64:67], a[228:231], v[148:151]
  ds_read_b128 v[116:119], v14 offset:15360
  v_mfma_f32_16x16x32_bf16 v[152:155], v[64:67], a[232:235], v[152:155]
  ds_read_b128 v[116:119], v14 offset:15360
  v_mfma_f32_16x16x32_bf16 v[156:159], v[64:67], a[236:239], v[156:159]
  v_mfma_f32_16x16x32_bf16 v[160:163], v[64:67], a[240:243], v[160:163]
  v_mfma_f32_16x16x32_bf16 v[164:167], v[64:67], a[244:247], v[164:167]
  v_mfma_f32_16x16x32_bf16 v[168:171], v[64:67], a[248:251], v[168:171]
  v_mfma_f32_16x16x32_bf16 v[172:175], v[64:67], a[252:255], v[172:175]
  v_mfma_f32_16x16x32_bf16 v[176:179], v[64:67], v[244:247], v[176:179]
  s_waitcnt lgkmcnt(0)
  v_mfma_f32_16x16x32_bf16 v[180:183], v[88:91], a[0:3], 0
  v_mfma_f32_16x16x32_bf16 v[184:187], v[88:91], a[4:7], 0
  v_mfma_f32_16x16x32_bf16 v[188:191], v[88:91], a[8:11], 0
  v_mfma_f32_16x16x32_bf16 v[192:195], v[88:91], a[12:15], 0
  v_mfma_f32_16x16x32_bf16 v[196:199], v[88:91], a[16:19], 0
  v_mfma_f32_16x16x32_bf16 v[200:203], v[88:91], a[20:23], 0
  v_mfma_f32_16x16x32_bf16 v[204:207], v[88:91], a[24:27], 0
  v_mfma_f32_16x16x32_bf16 v[208:211], v[88:91], a[28:31], 0
  v_mfma_f32_16x16x32_bf16 v[212:215], v[88:91], v[216:219], 0
  v_mfma_f32_16x16x32_bf16 v[180:183], v[92:95], a[32:35], v[180:183]
  v_mfma_f32_16x16x32_bf16 v[184:187], v[92:95], a[36:39], v[184:187]
  v_cvt_pk_bf16_f32 v120, v144, v148
  v_mfma_f32_16x16x32_bf16 v[188:191], v[92:95], a[40:43], v[188:191]
  v_cvt_pk_bf16_f32 v121, v152, v156
  v_mfma_f32_16x16x32_bf16 v[192:195], v[92:95], a[44:47], v[192:195]
  v_cvt_pk_bf16_f32 v122, v160, v164
  v_mfma_f32_16x16x32_bf16 v[196:199], v[92:95], a[48:51], v[196:199]
  v_cvt_pk_bf16_f32 v123, v168, v172
  v_mfma_f32_16x16x32_bf16 v[200:203], v[92:95], a[52:55], v[200:203]
  buffer_store_dwordx4 v[120:123], v1, s[20:23], s44 offen offset:0 sc1
  v_mfma_f32_16x16x32_bf16 v[204:207], v[92:95], a[56:59], v[204:207]
  v_cvt_pk_bf16_f32 v124, v145, v149
  v_mfma_f32_16x16x32_bf16 v[208:211], v[92:95], a[60:63], v[208:211]
  v_cvt_pk_bf16_f32 v125, v153, v157
  v_mfma_f32_16x16x32_bf16 v[212:215], v[92:95], v[220:223], v[212:215]
  v_cvt_pk_bf16_f32 v126, v161, v165
  v_mfma_f32_16x16x32_bf16 v[180:183], v[96:99], a[64:67], v[180:183]
  v_cvt_pk_bf16_f32 v127, v169, v173
  v_mfma_f32_16x16x32_bf16 v[184:187], v[96:99], a[68:71], v[184:187]
  buffer_store_dwordx4 v[124:127], v1, s[20:23], s44 offen offset:1024 sc1
  v_mfma_f32_16x16x32_bf16 v[188:191], v[96:99], a[72:75], v[188:191]
  v_cvt_pk_bf16_f32 v128, v146, v150
  v_mfma_f32_16x16x32_bf16 v[192:195], v[96:99], a[76:79], v[192:195]
  v_cvt_pk_bf16_f32 v129, v154, v158
  v_mfma_f32_16x16x32_bf16 v[196:199], v[96:99], a[80:83], v[196:199]
  v_cvt_pk_bf16_f32 v130, v162, v166
  v_mfma_f32_16x16x32_bf16 v[200:203], v[96:99], a[84:87], v[200:203]
  v_cvt_pk_bf16_f32 v131, v170, v174
  v_mfma_f32_16x16x32_bf16 v[204:207], v[96:99], a[88:91], v[204:207]
  buffer_store_dwordx4 v[128:131], v1, s[20:23], s44 offen offset:2048 sc1
  v_mfma_f32_16x16x32_bf16 v[208:211], v[96:99], a[92:95], v[208:211]
  v_cvt_pk_bf16_f32 v132, v147, v151
  v_mfma_f32_16x16x32_bf16 v[212:215], v[96:99], v[224:227], v[212:215]
  v_cvt_pk_bf16_f32 v133, v155, v159
  v_mfma_f32_16x16x32_bf16 v[180:183], v[100:103], a[96:99], v[180:183]
  v_cvt_pk_bf16_f32 v134, v163, v167
  v_mfma_f32_16x16x32_bf16 v[184:187], v[100:103], a[100:103], v[184:187]
  v_cvt_pk_bf16_f32 v135, v171, v175
  v_mfma_f32_16x16x32_bf16 v[188:191], v[100:103], a[104:107], v[188:191]
  buffer_store_dwordx4 v[132:135], v1, s[20:23], s44 offen offset:3072 sc1
  v_mfma_f32_16x16x32_bf16 v[192:195], v[100:103], a[108:111], v[192:195]
  s_add_u32 s44, s44, 4096
  v_mfma_f32_16x16x32_bf16 v[196:199], v[100:103], a[112:115], v[196:199]
  v_cvt_pk_bf16_f32 v136, v176, v177
  v_mfma_f32_16x16x32_bf16 v[200:203], v[100:103], a[116:119], v[200:203]
  v_cvt_pk_bf16_f32 v137, v178, v179
  v_mfma_f32_16x16x32_bf16 v[204:207], v[100:103], a[120:123], v[204:207]
  s_lshl_b32 s45, s34, 13
  v_mfma_f32_16x16x32_bf16 v[208:211], v[100:103], a[124:127], v[208:211]
  s_lshl_b32 s49, s32, 7
  v_mfma_f32_16x16x32_bf16 v[212:215], v[100:103], v[228:231], v[212:215]
  s_add_u32 s45, s45, s49
  v_mfma_f32_16x16x32_bf16 v[180:183], v[104:107], a[128:131], v[180:183]
  s_lshl_b32 s49, s46, 3
  v_mfma_f32_16x16x32_bf16 v[184:187], v[104:107], a[132:135], v[184:187]
  s_add_u32 s45, s45, s49
  v_mfma_f32_16x16x32_bf16 v[188:191], v[104:107], a[136:139], v[188:191]
  s_add_u32 s45, s45, 13631488
  v_mfma_f32_16x16x32_bf16 v[192:195], v[104:107], a[140:143], v[192:195]
  v_lshlrev_b32 v8, 9, v254
  v_mfma_f32_16x16x32_bf16 v[196:199], v[104:107], a[144:147], v[196:199]
  s_memrealtime s[28:29]
  v_mfma_f32_16x16x32_bf16 v[200:203], v[104:107], a[148:151], v[200:203]
  v_mfma_f32_16x16x32_bf16 v[204:207], v[104:107], a[152:155], v[204:207]
  v_mfma_f32_16x16x32_bf16 v[208:211], v[104:107], a[156:159], v[208:211]
  v_mfma_f32_16x16x32_bf16 v[212:215], v[104:107], v[232:235], v[212:215]
  v_mfma_f32_16x16x32_bf16 v[180:183], v[108:111], a[160:163], v[180:183]
  v_mfma_f32_16x16x32_bf16 v[184:187], v[108:111], a[164:167], v[184:187]
  v_mfma_f32_16x16x32_bf16 v[188:191], v[108:111], a[168:171], v[188:191]
  v_mfma_f32_16x16x32_bf16 v[192:195], v[108:111], a[172:175], v[192:195]
  v_mfma_f32_16x16x32_bf16 v[196:199], v[108:111], a[176:179], v[196:199]
  v_mfma_f32_16x16x32_bf16 v[200:203], v[108:111], a[180:183], v[200:203]
  v_mfma_f32_16x16x32_bf16 v[204:207], v[108:111], a[184:187], v[204:207]
  v_mfma_f32_16x16x32_bf16 v[208:211], v[108:111], a[188:191], v[208:211]
  v_mfma_f32_16x16x32_bf16 v[212:215], v[108:111], v[236:239], v[212:215]
  v_mfma_f32_16x16x32_bf16 v[180:183], v[112:115], a[192:195], v[180:183]
  v_mfma_f32_16x16x32_bf16 v[184:187], v[112:115], a[196:199], v[184:187]
  v_mfma_f32_16x16x32_bf16 v[188:191], v[112:115], a[200:203], v[188:191]
  v_mfma_f32_16x16x32_bf16 v[192:195], v[112:115], a[204:207], v[192:195]
  v_mfma_f32_16x16x32_bf16 v[196:199], v[112:115], a[208:211], v[196:199]
  v_mfma_f32_16x16x32_bf16 v[200:203], v[112:115], a[212:215], v[200:203]
  v_mfma_f32_16x16x32_bf16 v[204:207], v[112:115], a[216:219], v[204:207]
  v_mfma_f32_16x16x32_bf16 v[208:211], v[112:115], a[220:223], v[208:211]
  v_mfma_f32_16x16x32_bf16 v[212:215], v[112:115], v[240:243], v[212:215]
  v_mfma_f32_16x16x32_bf16 v[180:183], v[116:119], a[224:227], v[180:183]
  v_mfma_f32_16x16x32_bf16 v[184:187], v[116:119], a[228:231], v[184:187]
  v_mfma_f32_16x16x32_bf16 v[188:191], v[116:119], a[232:235], v[188:191]
  v_mfma_f32_16x16x32_bf16 v[192:195], v[116:119], a[236:239], v[192:195]
  v_mfma_f32_16x16x32_bf16 v[196:199], v[116:119], a[240:243], v[196:199]
  v_mfma_f32_16x16x32_bf16 v[200:203], v[116:119], a[244:247], v[200:203]
  v_mfma_f32_16x16x32_bf16 v[204:207], v[116:119], a[248:251], v[204:207]
  v_mfma_f32_16x16x32_bf16 v[208:211], v[116:119], a[252:255], v[208:211]
  v_mfma_f32_16x16x32_bf16 v[212:215], v[116:119], v[244:247], v[212:215]
  s_nop 7
  v_cvt_pk_bf16_f32 v120, v180, v184
  v_cvt_pk_bf16_f32 v121, v188, v192
  v_cvt_pk_bf16_f32 v122, v196, v200
  v_cvt_pk_bf16_f32 v123, v204, v208
  buffer_store_dwordx4 v[120:123], v1, s[20:23], s44 offen offset:0 sc1
  v_cvt_pk_bf16_f32 v124, v181, v185
  v_cvt_pk_bf16_f32 v125, v189, v193
  v_cvt_pk_bf16_f32 v126, v197, v201
  v_cvt_pk_bf16_f32 v127, v205, v209
  buffer_store_dwordx4 v[124:127], v1, s[20:23], s44 offen offset:1024 sc1
  v_cvt_pk_bf16_f32 v128, v182, v186
  v_cvt_pk_bf16_f32 v129, v190, v194
  v_cvt_pk_bf16_f32 v130, v198, v202
  v_cvt_pk_bf16_f32 v131, v206, v210
  buffer_store_dwordx4 v[128:131], v1, s[20:23], s44 offen offset:2048 sc1
  v_cvt_pk_bf16_f32 v132, v183, v187
  v_cvt_pk_bf16_f32 v133, v191, v195
  v_cvt_pk_bf16_f32 v134, v199, v203
  v_cvt_pk_bf16_f32 v135, v207, v211
  buffer_store_dwordx4 v[132:135], v1, s[20:23], s44 offen offset:3072 sc1
  s_add_u32 s44, s44, 4096
  v_cvt_pk_bf16_f32 v138, v212, v213
  v_cvt_pk_bf16_f32 v139, v214, v215
  buffer_store_dwordx4 v[136:139], v1, s[20:23], s44 offen sc1
  s_waitcnt lgkmcnt(0)
  v_mov_b32 v10, s28
  v_mov_b32 v11, s29
  s_waitcnt vmcnt(0)
  s_mov_b64 exec, 0xffff
  buffer_store_dwordx2 v[10:11], v8, s[20:23], s45 offen sc1
  s_mov_b64 exec, -1
  s_branch L_fin
L_g2_tail:
  v_mov_b32 v219, s28
  v_mov_b32 v223, s28
  v_mov_b32 v227, s28
  v_mov_b32 v231, s28
  v_mov_b32 v235, s28
  s_waitcnt lgkmcnt(8)
  v_mfma_f32_32x32x16_bf16 v[120:135], v[192:195], v[156:159], v[120:135]
  v_mov_b32 v239, s28
  v_mov_b32 v237, v3
  v_mov_b32 v238, v71
  s_add_u32 s40, s49, 4096
  s_add_u32 s37, s49, 8192
  s_nop 0
  v_mfma_f32_32x32x16_bf16 v[136:151], v[196:199], v[156:159], v[136:151]
  s_nop 3
  s_nop 0
  s_nop 0
  s_nop 0
  s_nop 0
  s_nop 0
  s_waitcnt lgkmcnt(4)
  v_mfma_f32_32x32x16_bf16 v[88:103], v[200:203], v[152:155], v[88:103]
  s_nop 3
  v_mfma_f32_32x32x16_bf16 v[104:119], v[204:207], v[152:155], v[104:119]
  s_waitcnt lgkmcnt(0)
  ds_write_b128 v11, v[120:123] offset:0
  ds_write_b128 v11, v[124:127] offset:1024
  ds_write_b128 v11, v[128:131] offset:2048
  ds_write_b128 v11, v[132:135] offset:3072
  v_mfma_f32_32x32x16_bf16 v[88:103], v[208:211], v[156:159], v[88:103]
  ds_write_b128 v11, v[136:139] offset:4096
  ds_write_b128 v11, v[140:143] offset:5120
  ds_write_b128 v11, v[144:147] offset:6144
  ds_write_b128 v11, v[148:151] offset:7168
  v_mfma_f32_32x32x16_bf16 v[104:119], v[212:215], v[156:159], v[104:119]
  s_waitcnt lgkmcnt(0)
  s_barrier
  ds_read_b128 v[120:123], v70 offset:0
  ds_read_b128 v[124:127], v70 offset:1024
  ds_read_b128 v[128:131], v70 offset:2048
  ds_read_b128 v[132:135], v70 offset:3072
  ds_read_b128 v[136:139], v70 offset:4096
  ds_read_b128 v[140:143], v70 offset:5120
  ds_read_b128 v[144:147], v70 offset:6144
  ds_read_b128 v[148:151], v70 offset:7168
  s_waitcnt lgkmcnt(7)
  v_pk_add_f32 v[88:89], v[88:89], v[120:121]
  v_pk_add_f32 v[90:91], v[90:91], v[122:123]
  v_cvt_pk_bf16_f32 v216, v88, v89
  v_cvt_pk_bf16_f32 v217, v90, v91
  s_waitcnt lgkmcnt(6)
  v_pk_add_f32 v[92:93], v[92:93], v[124:125]
  v_pk_add_f32 v[94:95], v[94:95], v[126:127]
  v_cvt_pk_bf16_f32 v218, v92, v93
  buffer_store_dwordx4 v[216:219], v1, s[20:23], s49 offen offset:0 sc1
  v_cvt_pk_bf16_f32 v220, v94, v95
  s_waitcnt lgkmcnt(5)
  v_pk_add_f32 v[96:97], v[96:97], v[128:129]
  v_pk_add_f32 v[98:99], v[98:99], v[130:131]
  v_cvt_pk_bf16_f32 v221, v96, v97
  v_cvt_pk_bf16_f32 v222, v98, v99
  buffer_store_dwordx4 v[220:223], v1, s[20:23], s49 offen offset:1024 sc1
  s_waitcnt lgkmcnt(4)
  v_pk_add_f32 v[100:101], v[100:101], v[132:133]
  v_pk_add_f32 v[102:103], v[102:103], v[134:135]
  v_cvt_pk_bf16_f32 v224, v100, v101
  v_cvt_pk_bf16_f32 v225, v102, v103
  s_waitcnt lgkmcnt(3)
  v_pk_add_f32 v[104:105], v[104:105], v[136:137]
  v_pk_add_f32 v[106:107], v[106:107], v[138:139]
  v_cvt_pk_bf16_f32 v226, v104, v105
  buffer_store_dwordx4 v[224:227], v1, s[20:23], s49 offen offset:2048 sc1
  v_cvt_pk_bf16_f32 v228, v106, v107
  s_waitcnt lgkmcnt(2)
  v_pk_add_f32 v[108:109], v[108:109], v[140:141]
  v_pk_add_f32 v[110:111], v[110:111], v[142:143]
  v_cvt_pk_bf16_f32 v229, v108, v109
  v_cvt_pk_bf16_f32 v230, v110, v111
  buffer_store_dwordx4 v[228:231], v1, s[20:23], s49 offen offset:3072 sc1
  s_waitcnt lgkmcnt(1)
  v_pk_add_f32 v[112:113], v[112:113], v[144:145]
  v_pk_add_f32 v[114:115], v[114:115], v[146:147]
  v_cvt_pk_bf16_f32 v232, v112, v113
  v_cvt_pk_bf16_f32 v233, v114, v115
  s_waitcnt lgkmcnt(0)
  v_pk_add_f32 v[116:117], v[116:117], v[148:149]
  v_pk_add_f32 v[118:119], v[118:119], v[150:151]
  v_cvt_pk_bf16_f32 v234, v116, v117
  buffer_store_dwordx4 v[232:235], v1, s[20:23], s40 offen offset:0 sc1
  v_cvt_pk_bf16_f32 v236, v118, v119
  buffer_store_dwordx4 v[236:239], v1, s[20:23], s40 offen offset:1024 sc1
  s_mov_b32 s12, s90
  s_and_b32 s13, s91, 0xffff
  s_mov_b32 s14, 0x48000
  s_mov_b32 s15, 0x20000
  s_and_b32 s52, s2, 15
  v_and_b32 v8, 1, v254
  v_lshlrev_b32 v8, 4, v8
  v_mov_b32 v9, 0x3f80
  v_lshlrev_b32 v9, v8, v9
  v_lshrrev_b32 v8, 1, v254
  v_cmp_eq_u32 vcc, 0, v8
  s_nop 1
  v_cndmask_b32 v36, 0, v9, vcc
  v_cmp_eq_u32 vcc, 1, v8
  s_nop 1
  v_cndmask_b32 v37, 0, v9, vcc
  v_cmp_eq_u32 vcc, 2, v8
  s_nop 1
  v_cndmask_b32 v38, 0, v9, vcc
  v_cmp_eq_u32 vcc, 3, v8
  s_nop 1
  v_cndmask_b32 v39, 0, v9, vcc
  s_lshl_b32 s44, s34, 4
  s_add_u32 s44, s44, s52
  s_lshl_b32 s44, s44, 2
  s_add_u32 s44, s44, s32
  s_lshl_b32 s44, s44, 7
  s_add_u32 s49, s44, 13631488
  v_lshlrev_b32 v9, 3, v254
  v_mul_u32_u24 v8, 36864, v253
  v_lshl_add_u32 v8, v254, 4, v8
  s_mul_i32 s44, s34, 589824
  s_mul_i32 s45, s32, 9216
  s_add_u32 s44, s44, s45
  s_add_u32 s44, s44, 16777216
  s_lshl_b32 s45, s52, 8
  s_add_u32 s50, s44, s45
  s_add_u32 s50, s50, 8192
  s_lshl_b32 s45, s52, 9
  s_add_u32 s44, s44, s45
  s_lshr_b32 s45, s52, 3
  s_lshl_b32 s45, s45, 4
  s_and_b32 s46, s52, 1
  s_lshl_b32 s46, s46, 3
  s_add_u32 s45, s45, s46
  s_bfe_u32 s46, s52, 0x20001
  s_add_u32 s45, s45, s46
  s_lshl_b32 s46, s34, 5
  s_add_u32 s45, s45, s46
  s_mul_i32 s45, s45, 1152
  s_lshl_b32 s46, s32, 8
  s_add_u32 s45, s45, s46
  s_add_u32 s36, s45, 4608
  v_lshlrev_b32 v25, 4, v254
  v_lshl_add_u32 v25, v253, 3, v25
  s_mov_b32 s46, 0
  s_mov_b64 s[26:27], s[30:31]
  s_branch L_polly_ld
L_polly:
  s_sleep 1
  s_and_b32 s96, s46, 63
  s_cbranch_scc1 L_noely
  s_lshl_b32 s96, s34, 5
  buffer_load_dwordx2 v[10:11], off, s[92:95], s96 sc1
  s_waitcnt vmcnt(0)
  v_readfirstlane_b32 s96, v10
  v_readfirstlane_b32 s97, v11
  s_nop 1
  s_not_b64 s[96:97], s[96:97]
  s_sub_u32 s3, s96, s26
  s_subb_u32 s3, s97, s27
  s_cselect_b64 s[26:27], s[96:97], s[26:27]
L_noely:
L_polly_ld:
  buffer_load_dwordx2 v[10:11], v9, s[20:23], s49 offen sc1
  v_mov_b32 v27, s27
  s_waitcnt vmcnt(0)
  v_subrev_co_u32 v26, vcc, s26, v10
  v_subb_co_u32 v27, vcc, v11, v27, vcc
  v_cmp_le_u64 vcc, s[24:25], v[26:27]
  s_add_u32 s46, s46, 1
  s_cbranch_vccz L_polly_done
  s_cmp_lt_u32 s46, 1048576
  s_cbranch_scc1 L_polly
L_polly_done:
  buffer_load_dwordx4 v[88:91], v8, s[20:23], s44 offen sc1
  buffer_load_dwordx4 v[104:107], v8, s[20:23], s44 offen offset:256 sc1
  s_add_u32 s44, s44, 147456
  buffer_load_dwordx4 v[92:95], v8, s[20:23], s44 offen sc1
  buffer_load_dwordx4 v[108:111], v8, s[20:23], s44 offen offset:256 sc1
  s_add_u32 s44, s44, 147456
  buffer_load_dwordx4 v[96:99], v8, s[20:23], s44 offen sc1
  buffer_load_dwordx4 v[112:115], v8, s[20:23], s44 offen offset:256 sc1
  s_add_u32 s44, s44, 147456
  buffer_load_dwordx4 v[100:103], v8, s[20:23], s44 offen sc1
  buffer_load_dwordx4 v[116:119], v8, s[20:23], s44 offen offset:256 sc1
  s_add_u32 s44, s44, 147456
  s_cmp_lt_u32 s52, 4
  s_cbranch_scc0 L_no_extra_ld
  buffer_load_dwordx4 v[120:123], v8, s[20:23], s50 offen sc1
  s_add_u32 s50, s50, 147456
  buffer_load_dwordx4 v[124:127], v8, s[20:23], s50 offen sc1
  s_add_u32 s50, s50, 147456
  buffer_load_dwordx4 v[128:131], v8, s[20:23], s50 offen sc1
  s_add_u32 s50, s50, 147456
  buffer_load_dwordx4 v[132:135], v8, s[20:23], s50 offen sc1
  s_add_u32 s50, s50, 147456
L_no_extra_ld:
  s_waitcnt vmcnt(0)
  v_mfma_f32_16x16x32_bf16 v[152:155], v[36:39], v[88:91], 0
  v_mfma_f32_16x16x32_bf16 v[156:159], v[36:39], v[104:107], 0
  v_mfma_f32_16x16x32_bf16 v[152:155], v[36:39], v[92:95], v[152:155]
  v_mfma_f32_16x16x32_bf16 v[156:159], v[36:39], v[108:111], v[156:159]
  v_mfma_f32_16x16x32_bf16 v[152:155], v[36:39], v[96:99], v[152:155]
  v_mfma_f32_16x16x32_bf16 v[156:159], v[36:39], v[112:115], v[156:159]
  v_mfma_f32_16x16x32_bf16 v[152:155], v[36:39], v[100:103], v[152:155]
  v_mfma_f32_16x16x32_bf16 v[156:159], v[36:39], v[116:119], v[156:159]
  s_nop 7
  v_cvt_pk_bf16_f32 v168, v152, v153
  v_cvt_pk_bf16_f32 v169, v154, v155
  v_cvt_pk_bf16_f32 v170, v156, v157
  v_cvt_pk_bf16_f32 v171, v158, v159
  s_mov_b32 exec_hi, 0
  buffer_store_dwordx2 v[168:169], v25, s[12:15], s45 offen
  buffer_store_dwordx2 v[170:171], v25, s[12:15], s36 offen
  s_mov_b64 exec, -1
  s_cmp_lt_u32 s52, 4
  s_cbranch_scc0 L_fin
  v_mfma_f32_16x16x32_bf16 v[160:163], v[36:39], v[120:123], 0
  v_mfma_f32_16x16x32_bf16 v[160:163], v[36:39], v[124:127], v[160:163]
  v_mfma_f32_16x16x32_bf16 v[160:163], v[36:39], v[128:131], v[160:163]
  v_mfma_f32_16x16x32_bf16 v[160:163], v[36:39], v[132:135], v[160:163]
  s_lshl_b32 s44, s52, 2
  s_lshl_b32 s45, s34, 5
  s_add_u32 s44, s44, s45
  s_mul_i32 s44, s44, 1152
  s_lshl_b32 s45, s32, 5
  s_add_u32 s44, s44, s45
  s_add_u32 s44, s44, 1024
  v_lshlrev_b32 v8, 1, v254
  v_mul_u32_u24 v9, 18432, v253
  v_add_u32 v8, v8, v9
  s_nop 3
  v_cvt_pk_bf16_f32 v164, v160, v161
  v_cvt_pk_bf16_f32 v165, v162, v163
  s_mov_b32 exec_hi, 0
  buffer_store_short v164, v8, s[12:15], s44 offen
  buffer_store_short_d16_hi v164, v8, s[12:15], s44 offen offset:1152
  buffer_store_short v165, v8, s[12:15], s44 offen offset:2304
  buffer_store_short_d16_hi v165, v8, s[12:15], s44 offen offset:3456
  s_mov_b64 exec, -1
L_fin:
L_end:
  s_endpgm
L_rescale:
  v_max_f32 v25, v25, v3
  v_mul_f32 v24, s41, v25
  v_fma_f32 v26, v3, s41, -v24
  v_exp_f32 v26, v26
  v_mov_b32 v3, v25
  s_nop 7
  v_pk_mul_f32 v[120:121], v[120:121], v[26:27] op_sel_hi:[1,0]
  v_pk_mul_f32 v[122:123], v[122:123], v[26:27] op_sel_hi:[1,0]
  v_pk_mul_f32 v[124:125], v[124:125], v[26:27] op_sel_hi:[1,0]
  v_pk_mul_f32 v[126:127], v[126:127], v[26:27] op_sel_hi:[1,0]
  v_pk_mul_f32 v[128:129], v[128:129], v[26:27] op_sel_hi:[1,0]
  v_pk_mul_f32 v[130:131], v[130:131], v[26:27] op_sel_hi:[1,0]
  v_pk_mul_f32 v[132:133], v[132:133], v[26:27] op_sel_hi:[1,0]
  v_pk_mul_f32 v[134:135], v[134:135], v[26:27] op_sel_hi:[1,0]
  v_pk_mul_f32 v[136:137], v[136:137], v[26:27] op_sel_hi:[1,0]
  v_pk_mul_f32 v[138:139], v[138:139], v[26:27] op_sel_hi:[1,0]
  v_pk_mul_f32 v[140:141], v[140:141], v[26:27] op_sel_hi:[1,0]
  v_pk_mul_f32 v[142:143], v[142:143], v[26:27] op_sel_hi:[1,0]
  v_pk_mul_f32 v[144:145], v[144:145], v[26:27] op_sel_hi:[1,0]
  v_pk_mul_f32 v[146:147], v[146:147], v[26:27] op_sel_hi:[1,0]
  v_pk_mul_f32 v[148:149], v[148:149], v[26:27] op_sel_hi:[1,0]
  v_pk_mul_f32 v[150:151], v[150:151], v[26:27] op_sel_hi:[1,0]
  v_pk_mul_f32 v[88:89], v[88:89], v[26:27] op_sel_hi:[1,0]
  v_pk_mul_f32 v[90:91], v[90:91], v[26:27] op_sel_hi:[1,0]
  v_pk_mul_f32 v[92:93], v[92:93], v[26:27] op_sel_hi:[1,0]
  v_pk_mul_f32 v[94:95], v[94:95], v[26:27] op_sel_hi:[1,0]
  v_pk_mul_f32 v[96:97], v[96:97], v[26:27] op_sel_hi:[1,0]
  v_pk_mul_f32 v[98:99], v[98:99], v[26:27] op_sel_hi:[1,0]
  v_pk_mul_f32 v[100:101], v[100:101], v[26:27] op_sel_hi:[1,0]
  v_pk_mul_f32 v[102:103], v[102:103], v[26:27] op_sel_hi:[1,0]
  v_pk_mul_f32 v[104:105], v[104:105], v[26:27] op_sel_hi:[1,0]
  v_pk_mul_f32 v[106:107], v[106:107], v[26:27] op_sel_hi:[1,0]
  v_pk_mul_f32 v[108:109], v[108:109], v[26:27] op_sel_hi:[1,0]
  v_pk_mul_f32 v[110:111], v[110:111], v[26:27] op_sel_hi:[1,0]
  v_pk_mul_f32 v[112:113], v[112:113], v[26:27] op_sel_hi:[1,0]
  v_pk_mul_f32 v[114:115], v[114:115], v[26:27] op_sel_hi:[1,0]
  v_pk_mul_f32 v[116:117], v[116:117], v[26:27] op_sel_hi:[1,0]
  v_pk_mul_f32 v[118:119], v[118:119], v[26:27] op_sel_hi:[1,0]
  v_pk_mul_f32 v[32:33], v[32:33], v[26:27] op_sel_hi:[1,0]
  v_pk_mul_f32 v[34:35], v[34:35], v[26:27] op_sel_hi:[1,0]
  s_setpc_b64 s[96:97]
L_pollo:
  s_mov_b32 s45, 0
L_pollo2:
  buffer_load_dwordx4 v[216:219], v1, s[20:23], s52 offen offset:0 sc1
  buffer_load_dwordx4 v[220:223], v1, s[20:23], s52 offen offset:1024 sc1
  buffer_load_dwordx4 v[224:227], v1, s[20:23], s52 offen offset:2048 sc1
  buffer_load_dwordx4 v[228:231], v1, s[20:23], s52 offen offset:3072 sc1
  buffer_load_dwordx4 v[232:235], v1, s[20:23], s40 offen offset:0 sc1
  buffer_load_dwordx4 v[236:239], v1, s[20:23], s40 offen offset:1024 sc1
  s_waitcnt vmcnt(0)
  v_xor_b32 v219, v219, v15
  v_xor_b32 v223, v223, v15
  v_xor_b32 v227, v227, v15
  v_xor_b32 v231, v231, v15
  v_xor_b32 v235, v235, v15
  v_xor_b32 v239, v239, v15
  v_or3_b32 v219, v219, v223, v227
  v_or3_b32 v231, v231, v235, v239
  v_or_b32 v219, v219, v231
  v_cmp_ne_u32 vcc, 0, v219
  s_add_u32 s45, s45, 1
  s_cbranch_vccz L_pollo3
  s_sleep 1
  s_cmp_lt_u32 s45, 1048576
  s_cbranch_scc1 L_pollo2
L_pollo3:
  v_max_f32 v25, v3, v237
  v_mul_f32 v24, s41, v25
  v_fma_f32 v26, v3, s41, -v24
  v_fma_f32 v27, v237, s41, -v24
  v_exp_f32 v26, v26
  v_exp_f32 v27, v27
  v_and_b32 v37, 0xffff0000, v216
  v_lshlrev_b32 v36, 16, v216
  v_mul_f32 v25, v27, v238
  v_fma_f32 v25, v26, v71, v25
  v_rcp_f32 v25, v25
  v_and_b32 v39, 0xffff0000, v217
  v_lshlrev_b32 v38, 16, v217
  v_and_b32 v41, 0xffff0000, v218
  v_lshlrev_b32 v40, 16, v218
  v_and_b32 v43, 0xffff0000, v220
  v_lshlrev_b32 v42, 16, v220
  v_and_b32 v45, 0xffff0000, v221
  v_lshlrev_b32 v44, 16, v221
  v_and_b32 v47, 0xffff0000, v222
  v_lshlrev_b32 v46, 16, v222
  v_and_b32 v49, 0xffff0000, v224
  v_lshlrev_b32 v48, 16, v224
  v_and_b32 v51, 0xffff0000, v225
  v_lshlrev_b32 v50, 16, v225
  v_and_b32 v53, 0xffff0000, v226
  v_lshlrev_b32 v52, 16, v226
  v_and_b32 v55, 0xffff0000, v228
  v_lshlrev_b32 v54, 16, v228
  v_and_b32 v57, 0xffff0000, v229
  v_lshlrev_b32 v56, 16, v229
  v_and_b32 v59, 0xffff0000, v230
  v_lshlrev_b32 v58, 16, v230
  v_and_b32 v61, 0xffff0000, v232
  v_lshlrev_b32 v60, 16, v232
  v_and_b32 v63, 0xffff0000, v233
  v_lshlrev_b32 v62, 16, v233
  v_and_b32 v65, 0xffff0000, v234
  v_lshlrev_b32 v64, 16, v234
  v_and_b32 v67, 0xffff0000, v236
  v_lshlrev_b32 v66, 16, v236
  v_mul_f32 v26, v26, v25
  v_mul_f32 v27, v27, v25
  v_mul_f32 v36, v36, v27
  v_mul_f32 v37, v37, v27
  v_mul_f32 v38, v38, v27
  v_mul_f32 v39, v39, v27
  v_mul_f32 v40, v40, v27
  v_mul_f32 v41, v41, v27
  v_mul_f32 v42, v42, v27
  v_mul_f32 v43, v43, v27
  v_mul_f32 v44, v44, v27
  v_mul_f32 v45, v45, v27
  v_mul_f32 v46, v46, v27
  v_mul_f32 v47, v47, v27
  v_mul_f32 v48, v48, v27
  v_mul_f32 v49, v49, v27
  v_mul_f32 v50, v50, v27
  v_mul_f32 v51, v51, v27
  v_mul_f32 v52, v52, v27
  v_mul_f32 v53, v53, v27
  v_mul_f32 v54, v54, v27
  v_mul_f32 v55, v55, v27
  v_mul_f32 v56, v56, v27
  v_mul_f32 v57, v57, v27
  v_mul_f32 v58, v58, v27
  v_mul_f32 v59, v59, v27
  v_mul_f32 v60, v60, v27
  v_mul_f32 v61, v61, v27
  v_mul_f32 v62, v62, v27
  v_mul_f32 v63, v63, v27
  v_mul_f32 v64, v64, v27
  v_mul_f32 v65, v65, v27
  v_mul_f32 v66, v66, v27
  v_mul_f32 v67, v67, v27
  s_branch L_pollo_done
L_special:
  s_add_u32 s44, s50, 1024
  s_add_u32 s4, s88, s44
  s_addc_u32 s5, s89, 0
  s_sub_u32 s4, s4, 278528
  s_subb_u32 s5, s5, 0
  s_and_b32 s5, s5, 0xffff
  s_mov_b32 s6, 572416
  v_lshrrev_b32 v8, 3, v252
  v_mul_u32_u24 v8, 1152, v8
  v_and_b32 v9, 7, v252
  v_lshl_add_u32 v8, v9, 4, v8
  s_mul_i32 s44, s32, 32768
  v_add_u32 v4, s44, v8
  s_add_u32 s44, s44, 8192
  v_add_u32 v5, s44, v8
  s_add_u32 s44, s44, 8192
  v_add_u32 v6, s44, v8
  s_add_u32 s44, s44, 8192
  v_add_u32 v7, s44, v8
  s_add_u32 s44, s44, 8192
  s_branch L_special_ret
L_code_end:
.section .rodata,"a"
.p2align 6
.amdhsa_kernel standalone__sliding_block_cached__sampling_kernel
  .amdhsa_next_free_vgpr 512
  .amdhsa_next_free_sgpr 102
  .amdhsa_accum_offset 256
  .amdhsa_group_segment_fixed_size 0
  .amdhsa_kernarg_size 64
  .amdhsa_user_sgpr_count 2
  .amdhsa_user_sgpr_kernarg_segment_ptr 1
  .amdhsa_system_sgpr_workgroup_id_x 1
.end_amdhsa_kernel
```
